```python
import torch

def _softmax(x, axis=-1):
    return torch.softmax(x, dim=axis)
def _gelu(x):
    return torch.nn.functional.gelu(x, approximate="tanh")
def _silu(x):
    return torch.nn.functional.silu(x)
def _sigmoid(x):
    return torch.sigmoid(x)
def _layernorm(x, axis=-1, eps=1e-5):
    m = x.mean(dim=axis, keepdim=True)
    v = x.var(dim=axis, keepdim=True, unbiased=False)
    return (x - m) / torch.sqrt(v + eps)
def _scatter_add(tgt, idx, src, axis=0):
    return tgt.clone().index_add_(axis, idx, src)
def _segment_sum(src, seg, n):
    out = torch.zeros((n,) + src.shape[1:], dtype=src.dtype)
    return out.index_add_(0, seg, src)
def _pad(x, pw):
    flat = tuple(v for pair in reversed(pw) for v in pair)
    return torch.nn.functional.pad(x, flat)

kernel_name = 'interleave_layers__gqa_block_cached__mixer_token_mlp__decode'

def setup_inputs():

    _w = (lambda a: (lambda t: t.to(torch.bfloat16) if t.is_floating_point() else t)(torch.as_tensor(a)))
    def _A_setup():
        B, Sq, D = 8, 1, 448
        Hq, Hkv, Sk, Dh = 16, 8, 8192, 256
        assert Hq % Hkv == 0, (Hq, Hkv)
        return {
            "x": _w((lambda *s: torch.randn(*s, dtype=torch.bfloat16) * 0.05)(B, Sq, D)),
            "k_cache": _w((lambda *s: torch.randn(*s, dtype=torch.bfloat16) * 0.8)(B, Hkv, Sk, Dh)),
            "v_cache": _w((lambda *s: torch.randn(*s, dtype=torch.bfloat16) * 1.6)(B, Hkv, Sk, Dh)),
            "wq": _w((lambda *s: torch.randn(*s, dtype=torch.bfloat16) * 0.8)(D, Hq * Dh) * (D ** -0.5)),
            "wo": _w((lambda *s: torch.randn(*s, dtype=torch.bfloat16) * 1.6)(Hq * Dh, D) * ((Hq * Dh) ** -0.5)),
        }
    _A_in = _A_setup()

    def _B_setup():
        B, S, D, F = 8, 1, 448, 1792
        return {
            "x": _w((lambda *s: torch.randn(*s, dtype=torch.bfloat16) * 0.05)(B, S, D)),
            "w1": _w((lambda *s: torch.randn(*s, dtype=torch.bfloat16) * 0.8)(S, F) * (S ** -0.5)),
            "b1": _w((lambda *s: torch.randn(*s, dtype=torch.bfloat16) * 0.8)(F) * 0.02),
            "w2": _w((lambda *s: torch.randn(*s, dtype=torch.bfloat16) * 0.2)(F, S) * (F ** -0.5)),
            "b2": _w((lambda *s: torch.randn(*s, dtype=torch.bfloat16) * 0.2)(S) * 0.02),
        }
    _B_in = _B_setup()

    return {
        "A_x": _A_in["x"],
        "A_k_cache": _A_in["k_cache"],
        "A_v_cache": _A_in["v_cache"],
        "A_wq": _A_in["wq"],
        "A_wo": _A_in["wo"],
        "B_x": _B_in["x"],
        "B_w1": _B_in["w1"],
        "B_b1": _B_in["b1"],
        "B_w2": _B_in["w2"],
        "B_b2": _B_in["b2"],
    }

def reference(A_x, A_k_cache, A_v_cache, A_wq, A_wo, B_x, B_w1, B_b1, B_w2, B_b2):
    def _A_ref(x, k_cache, v_cache, wq, wo):
        B, Sq, D = x.shape
        Hq, Dh = 16, 256
        Hkv = k_cache.shape[1]
        rep = Hq // Hkv
        q = (lambda x, *d: x.permute(*d))((x @ wq).reshape(B, Sq, Hq, Dh), 0, 2, 1, 3)
        k = (lambda x, n, axis: torch.repeat_interleave(x, n, dim=axis))(k_cache, rep, axis=1)
        v = (lambda x, n, axis: torch.repeat_interleave(x, n, dim=axis))(v_cache, rep, axis=1)
        scores = torch.einsum("bhqd,bhkd->bhqk", q, k) * (Dh ** -0.5)
        p = _softmax(scores, axis=-1)
        o = torch.einsum("bhqk,bhkd->bhqd", p, v)
        return (lambda x, *d: x.permute(*d))(o, 0, 2, 1, 3).reshape(B, Sq, Hq * Dh) @ wo

    def _B_ref(x, w1, b1, w2, b2):
        B, S, D = x.shape
        h = _layernorm(x, axis=-1)
        u = torch.einsum("bsd,sf->bdf", h, w1) + b1
        u = _gelu(u)
        y = torch.einsum("bdf,fs->bds", u, w2) + b2
        return (lambda x, *d: x.permute(*d))(y, 0, 2, 1)

    x = A_x
    x = x + _A_ref(_layernorm(x, axis=-1), A_k_cache, A_v_cache, A_wq, A_wo)
    x = x + _B_ref(_layernorm(x, axis=-1), B_w1, B_b1, B_w2, B_b2)
    x = x + _A_ref(_layernorm(x, axis=-1), A_k_cache, A_v_cache, A_wq, A_wo)
    x = x + _B_ref(_layernorm(x, axis=-1), B_w1, B_b1, B_w2, B_b2)
    return x
```

```asm
; @launch grid=(256,1,1) block=(256,1,1) lds=160768
.amdgcn_target "amdgcn-amd-amdhsa--gfx950"
.text
.globl interleave_layers__gqa_block_cached__mixer_token_mlp__decode_kernel
.p2align 8
.type interleave_layers__gqa_block_cached__mixer_token_mlp__decode_kernel,@function
interleave_layers__gqa_block_cached__mixer_token_mlp__decode_kernel:
    s_cmp_ge_u32 s2, 256
    s_cbranch_scc1 L_exit
    s_load_dwordx16 s[16:31], s[0:1], 0
    s_load_dwordx8 s[32:39], s[0:1], 64
    s_load_dwordx2 s[40:41], s[0:1], 96
    v_lshrrev_b32 v1, 6, v0
    v_and_b32 v0, 63, v0
    v_readfirstlane_b32 s42, v1
    s_mov_b32 s45, s2
    s_and_b32 s43, s2, 7
    s_bfe_u32 s44, s2, 0x40003
    s_lshr_b32 s46, s2, 7
    v_lshrrev_b32 v6, 5, v0
    v_and_b32 v7, 31, v0
    v_xor_b32 v8, v7, v6
    v_lshlrev_b32 v8, 4, v8
    v_lshl_add_u32 v1, v6, 9, v8
    s_lshl_b32 s47, s43, 22
    s_lshl_b32 s76, s44, 18
    s_add_u32 s47, s47, s76
    s_lshl_b32 s76, s42, 10
    s_add_u32 s47, s47, s76
    s_lshl_b32 s76, s46, 25
    s_add_u32 s47, s47, s76
    s_lshl_b32 s48, s42, 15
    s_add_u32 s48, s48, 29696
    s_mov_b32 s10, 0x10000000
    s_mov_b32 s11, 0x00020000
    s_mov_b32 s6, 0x10000000
    s_mov_b32 s7, 0x00020000
    s_mov_b32 s14, 0x800000
    s_mov_b32 s15, 0x00020000
    v_lshlrev_b32 v8, 2, v6
    v_xor_b32 v8, v7, v8
    v_lshlrev_b32 v8, 4, v8
    v_lshl_add_u32 v2, v6, 9, v8
    v_and_b32 v6, 15, v0
    v_lshrrev_b32 v7, 4, v0
    v_xor_b32 v8, v6, v7
    v_lshlrev_b32 v8, 4, v8
    v_lshl_add_u32 v4, v6, 9, v8
    v_add_u32 v4, s48, v4
    v_lshrrev_b32 v8, 2, v6
    v_bfe_u32 v9, v0, 1, 1
    v_lshl_add_u32 v9, v7, 1, v9
    v_lshlrev_b32 v7, 2, v8
    v_xor_b32 v9, v9, v7
    v_lshlrev_b32 v9, 4, v9
    v_lshl_add_u32 v9, v8, 9, v9
    v_and_b32 v7, 1, v0
    v_lshl_add_u32 v5, v7, 3, v9
    v_add_u32 v5, s48, v5
    s_mov_b32 s54, s46
    s_mov_b32 s50, 0
    s_mov_b32 s56, 2000000
    s_mov_b32 s60, 0
    s_mov_b32 s58, 0x3db8aa3b
    s_lshl_b32 s53, s43, 11
    s_lshl_b32 s76, s44, 7
    s_add_u32 s53, s53, s76
    s_and_b32 s77, s45, 0x87
    s_lshl3_add_u32 s51, s46, s43
    s_lshl_b32 s52, s77, 11
    s_add_u32 s52, s52, s76
    s_lshl2_add_u32 s86, s45, s42
    s_lshl2_add_u32 s69, s86, 0x2ad000
    s_xor_b32 s70, s69, 2048
    s_lshl_b32 s76, s43, 9
    s_lshl_b32 s77, s44, 5
    s_add_u32 s78, s76, s77
    s_mul_i32 s49, s42, 917504
    s_lshl1_add_u32 s49, s78, s49
    s_lshl2_add_u32 s61, s43, s42
    s_mul_i32 s61, s61, 114688
    s_mul_i32 s77, s44, 56
    s_add_u32 s61, s61, s77
    s_mov_b32 s94, 3670016
    s_mov_b32 s95, 0x00020000
    s_getreg_b32 s90, hwreg(HW_REG_XCC_ID)
    s_waitcnt lgkmcnt(0)
    s_and_b32 s27, s90, 7
    s_mov_b64 s[4:5], s[18:19]
    s_mov_b64 s[12:13], s[40:41]
    s_mov_b64 s[8:9], s[20:21]
    s_mov_b64 s[92:93], s[24:25]
    s_cmp_lg_u32 s46, 0
    s_cbranch_scc1 L_n_1
    s_add_u32 m0, s48, 0
    v_xor_b32 v3, 0x0, v1
    buffer_load_dwordx4 v3, s[4:7], s47 offen nt lds
    s_add_u32 m0, s48, 1024
    v_xor_b32 v3, 0x1020, v1
    buffer_load_dwordx4 v3, s[4:7], s47 offen nt lds
    s_add_u32 m0, s48, 2048
    v_xor_b32 v3, 0x2040, v1
    buffer_load_dwordx4 v3, s[4:7], s47 offen nt lds
    s_add_u32 m0, s48, 3072
    v_xor_b32 v3, 0x3060, v1
    buffer_load_dwordx4 v3, s[4:7], s47 offen nt lds
    s_add_u32 m0, s48, 4096
    v_xor_b32 v3, 0x4080, v1
    buffer_load_dwordx4 v3, s[4:7], s47 offen nt lds
    s_add_u32 m0, s48, 5120
    v_xor_b32 v3, 0x50a0, v1
    buffer_load_dwordx4 v3, s[4:7], s47 offen nt lds
    s_add_u32 m0, s48, 6144
    v_xor_b32 v3, 0x60c0, v1
    buffer_load_dwordx4 v3, s[4:7], s47 offen nt lds
    s_add_u32 m0, s48, 7168
    v_xor_b32 v3, 0x70e0, v1
    buffer_load_dwordx4 v3, s[4:7], s47 offen nt lds
    s_add_u32 m0, s48, 8192
    v_xor_b32 v3, 0x8000, v1
    buffer_load_dwordx4 v3, s[4:7], s47 offen nt lds
    s_add_u32 m0, s48, 9216
    v_xor_b32 v3, 0x9020, v1
    buffer_load_dwordx4 v3, s[4:7], s47 offen nt lds
    s_add_u32 m0, s48, 10240
    v_xor_b32 v3, 0xa040, v1
    buffer_load_dwordx4 v3, s[4:7], s47 offen nt lds
    s_add_u32 m0, s48, 11264
    v_xor_b32 v3, 0xb060, v1
    buffer_load_dwordx4 v3, s[4:7], s47 offen nt lds
L_n_1:
    s_and_b32 s76, s45, 127
    s_mul_i32 s77, s76, 3856
    s_lshr_b32 s77, s77, 16
    s_mul_i32 s78, s77, 17
    s_lshl1_add_u32 s77, s77, s46
    s_cmp_eq_u32 s78, s76
    s_cselect_b32 s26, s77, 99
    v_mov_b32 v10, 0
    global_load_ushort v20, v10, s[34:35]
    s_cmp_lg_u32 s46, 0
    s_cbranch_scc1 L_late
    s_cmp_lg_u32 s42, 3
    s_cbranch_scc1 L_sk_2
    s_mul_i32 s76, s27, 6
    s_lshl_b64 s[78:79], 1, s76
    s_or_b32 s79, s79, 0x10000
    v_mov_b32 v62, s78
    v_mov_b32 v63, s79
    s_lshl_b32 s76, s43, 3
    v_mov_b32 v10, s76
    s_mov_b64 exec, 1
    global_atomic_add_x2 v[62:63], v10, v[62:63], s[38:39] sc0 sc1
    s_mov_b64 exec, -1
L_sk_2:
    s_add_u32 m0, s48, 12288
    v_xor_b32 v3, 0xc080, v1
    buffer_load_dwordx4 v3, s[4:7], s47 offen nt lds
    s_add_u32 m0, s48, 13312
    v_xor_b32 v3, 0xd0a0, v1
    buffer_load_dwordx4 v3, s[4:7], s47 offen nt lds
    s_add_u32 m0, s48, 14336
    v_xor_b32 v3, 0xe0c0, v1
    buffer_load_dwordx4 v3, s[4:7], s47 offen nt lds
    s_add_u32 m0, s48, 15360
    v_xor_b32 v3, 0xf0e0, v1
    buffer_load_dwordx4 v3, s[4:7], s47 offen nt lds
    s_add_u32 m0, s48, 16384
    v_xor_b32 v3, 0x10000, v1
    buffer_load_dwordx4 v3, s[4:7], s47 offen nt lds
    s_add_u32 m0, s48, 17408
    v_xor_b32 v3, 0x11020, v1
    buffer_load_dwordx4 v3, s[4:7], s47 offen nt lds
    s_add_u32 m0, s48, 18432
    v_xor_b32 v3, 0x12040, v1
    buffer_load_dwordx4 v3, s[4:7], s47 offen nt lds
    s_add_u32 m0, s48, 19456
    v_xor_b32 v3, 0x13060, v1
    buffer_load_dwordx4 v3, s[4:7], s47 offen nt lds
    s_add_u32 m0, s48, 20480
    v_xor_b32 v3, 0x14080, v1
    buffer_load_dwordx4 v3, s[4:7], s47 offen nt lds
    s_add_u32 m0, s48, 21504
    v_xor_b32 v3, 0x150a0, v1
    buffer_load_dwordx4 v3, s[4:7], s47 offen nt lds
    s_add_u32 m0, s48, 22528
    v_xor_b32 v3, 0x160c0, v1
    buffer_load_dwordx4 v3, s[4:7], s47 offen nt lds
    s_add_u32 m0, s48, 23552
    v_xor_b32 v3, 0x170e0, v1
    buffer_load_dwordx4 v3, s[4:7], s47 offen nt lds
    s_add_u32 m0, s48, 24576
    v_xor_b32 v3, 0x18000, v1
    buffer_load_dwordx4 v3, s[4:7], s47 offen nt lds
    s_add_u32 m0, s48, 25600
    v_xor_b32 v3, 0x19020, v1
    buffer_load_dwordx4 v3, s[4:7], s47 offen nt lds
    s_add_u32 m0, s48, 26624
    v_xor_b32 v3, 0x1a040, v1
    buffer_load_dwordx4 v3, s[4:7], s47 offen nt lds
    s_add_u32 m0, s48, 27648
    v_xor_b32 v3, 0x1b060, v1
    buffer_load_dwordx4 v3, s[4:7], s47 offen nt lds
    s_add_u32 m0, s48, 28672
    v_xor_b32 v3, 0x1c080, v1
    buffer_load_dwordx4 v3, s[4:7], s47 offen nt lds
    s_add_u32 m0, s48, 29696
    v_xor_b32 v3, 0x1d0a0, v1
    buffer_load_dwordx4 v3, s[4:7], s47 offen nt lds
    s_add_u32 m0, s48, 30720
    v_xor_b32 v3, 0x1e0c0, v1
    buffer_load_dwordx4 v3, s[4:7], s47 offen nt lds
    s_add_u32 m0, s48, 31744
    v_xor_b32 v3, 0x1f0e0, v1
    buffer_load_dwordx4 v3, s[4:7], s47 offen nt lds
    s_waitcnt vmcnt(16)
    v_lshlrev_b32 v20, 16, v20
    s_nop 0
    v_readfirstlane_b32 s57, v20
    s_cmp_lg_u32 s42, 3
    s_nop 2
    s_cbranch_scc1 L_sk_3
    v_readfirstlane_b32 s78, v62
    v_readfirstlane_b32 s79, v63
    s_nop 0
    s_lshr_b32 s76, s79, 16
    s_cmp_eq_u32 s76, 31
    s_nop 0
    s_cbranch_scc0 L_sk_3
    s_mul_i32 s76, s27, 6
    s_lshr_b64 s[78:79], s[78:79], s76
    s_and_b32 s76, s78, 63
    s_cmp_eq_u32 s76, 31
    s_cselect_b32 s76, 3, 2
    v_mov_b32 v11, s76
    s_lshl_b32 s76, s43, 2
    v_mov_b32 v10, s76
    s_mov_b64 exec, 1
    global_store_dword v10, v11, s[38:39] offset:128 sc1
    s_mov_b64 exec, -1
L_sk_3:
    s_branch L_fast2
L_late:
    v_min_u32 v10, 55, v0
    s_mul_i32 s76, s42, 1792
    v_lshl_add_u32 v10, v10, 4, s76
    global_load_dwordx4 v[48:51], v10, s[16:17]
    global_load_dwordx4 v[52:55], v10, s[16:17] offset:896
    v_lshrrev_b32 v6, 2, v0
    v_lshlrev_b32 v6, 13, v6
    v_and_b32 v7, 3, v0
    v_lshl_add_u32 v6, v7, 4, v6
    v_add_u32 v6, s49, v6
    s_add_u32 m0, s48, 24576
    s_nop 0
    global_load_lds_dwordx4 v6, s[22:23]
    s_add_u32 m0, s48, 25600
    v_add_u32 v6, 131072, v6
    global_load_lds_dwordx4 v6, s[22:23]
    s_add_u32 m0, s48, 26624
    v_add_u32 v6, 131072, v6
    global_load_lds_dwordx4 v6, s[22:23]
    s_add_u32 m0, s48, 27648
    v_add_u32 v6, 131072, v6
    global_load_lds_dwordx4 v6, s[22:23]
    s_add_u32 m0, s48, 28672
    v_add_u32 v6, 131072, v6
    global_load_lds_dwordx4 v6, s[22:23]
    s_add_u32 m0, s48, 29696
    v_add_u32 v6, 131072, v6
    global_load_lds_dwordx4 v6, s[22:23]
    s_add_u32 m0, s48, 30720
    v_add_u32 v6, 131072, v6
    global_load_lds_dwordx4 v6, s[22:23]
    v_lshlrev_b32 v10, 3, v0
    global_load_dwordx2 v[64:65], v10, s[28:29] offset:0
    global_load_dwordx2 v[66:67], v10, s[28:29] offset:512
    global_load_dwordx2 v[68:69], v10, s[28:29] offset:1024
    global_load_dwordx2 v[70:71], v10, s[28:29] offset:1536
    global_load_dwordx2 v[72:73], v10, s[28:29] offset:2048
    global_load_dwordx2 v[74:75], v10, s[28:29] offset:2560
    global_load_dwordx2 v[76:77], v10, s[28:29] offset:3072
    global_load_dwordx2 v[78:79], v10, s[30:31] offset:0
    global_load_dwordx2 v[80:81], v10, s[30:31] offset:512
    global_load_dwordx2 v[82:83], v10, s[30:31] offset:1024
    global_load_dwordx2 v[84:85], v10, s[30:31] offset:1536
    global_load_dwordx2 v[86:87], v10, s[30:31] offset:2048
    global_load_dwordx2 v[88:89], v10, s[30:31] offset:2560
    global_load_dwordx2 v[90:91], v10, s[30:31] offset:3072
    global_load_dwordx2 v[92:93], v10, s[32:33] offset:0
    global_load_dwordx2 v[94:95], v10, s[32:33] offset:512
    global_load_dwordx2 v[96:97], v10, s[32:33] offset:1024
    global_load_dwordx2 v[98:99], v10, s[32:33] offset:1536
    global_load_dwordx2 v[100:101], v10, s[32:33] offset:2048
    global_load_dwordx2 v[102:103], v10, s[32:33] offset:2560
    global_load_dwordx2 v[104:105], v10, s[32:33] offset:3072
    v_mov_b32 v12, 0
    v_mov_b32 v13, 0
    v_mov_b32 v14, 0
    v_mov_b32 v15, 0
    v_lshlrev_b32 v11, 4, v0
    v_lshrrev_b32 v10, 3, v0
    v_lshlrev_b32 v10, 14, v10
    v_and_b32 v16, 0x70, v11
    v_add_u32 v10, v10, v16
    s_lshl_b32 s76, s42, 17
    s_add_u32 s76, s76, s53
    s_add_u32 s76, s76, 0x220000
    s_cmp_eq_u32 s42, 0
    s_cbranch_scc1 L_n_4
    buffer_store_dwordx4 v[12:15], v10, s[12:15], s76 offen sc1
L_n_4:
    s_and_b32 s77, s42, 1
    s_lshr_b32 s78, s42, 1
    s_lshl_b32 s78, s78, 7
    s_xor_b32 s78, s78, s45
    s_lshl_b32 s76, s78, 11
    s_lshl_b32 s79, s77, 19
    s_add_u32 s76, s76, s79
    buffer_store_dwordx4 v[12:15], v11, s[12:15], s76 offen offset:0 sc1
    buffer_store_dwordx4 v[12:15], v11, s[12:15], s76 offen offset:1024 sc1
    s_lshl_b32 s76, s42, 14
    s_add_u32 s76, s76, s53
    s_lshr_b32 s77, s76, 4
    s_add_u32 s76, s76, 0x100000
    s_add_u32 s77, s77, 0x110000
    s_mov_b64 exec, 0xff
    buffer_store_dwordx4 v[12:15], v11, s[12:15], s76 offen sc1
    s_mov_b64 exec, 1
    buffer_store_dwordx2 v[12:13], off, s[12:15], s77 sc1
    s_mov_b64 exec, -1
    s_and_b32 s86, s86, 511
    s_mul_i32 s81, s86, 40
    s_add_u32 s81, s81, 0x2a0000
    v_lshlrev_b32 v10, 2, v0
    s_mov_b64 exec, 0x3ff
    buffer_store_dword v12, v10, s[12:15], s81 offen sc1
    s_mov_b64 exec, 1
    buffer_store_dword v12, off, s[12:15], s69 sc1
    buffer_store_dword v12, off, s[12:15], s70 sc1
    s_mov_b64 exec, -1
    s_waitcnt vmcnt(28)
    v_lshlrev_b32 v20, 16, v20
    s_nop 0
    v_readfirstlane_b32 s57, v20
    v_lshlrev_b32 v20, 16, v48
    v_and_b32 v21, 0xffff0000, v48
    v_lshlrev_b32 v22, 16, v49
    v_and_b32 v23, 0xffff0000, v49
    v_lshlrev_b32 v24, 16, v50
    v_and_b32 v25, 0xffff0000, v50
    v_lshlrev_b32 v26, 16, v51
    v_and_b32 v27, 0xffff0000, v51
    v_readlane_b32 s79, v20, 0
    v_cmp_gt_u32 vcc, 56, v0
    s_nop 0
    v_subrev_f32 v28, s79, v20
    v_subrev_f32 v29, s79, v21
    v_subrev_f32 v30, s79, v22
    v_subrev_f32 v31, s79, v23
    v_subrev_f32 v32, s79, v24
    v_subrev_f32 v33, s79, v25
    v_subrev_f32 v34, s79, v26
    v_subrev_f32 v35, s79, v27
    v_pk_mul_f32 v[38:39], v[28:29], v[28:29]
    v_pk_add_f32 v[36:37], v[28:29], v[30:31]
    v_pk_fma_f32 v[38:39], v[30:31], v[30:31], v[38:39]
    v_pk_fma_f32 v[38:39], v[32:33], v[32:33], v[38:39]
    v_pk_fma_f32 v[38:39], v[34:35], v[34:35], v[38:39]
    v_pk_add_f32 v[32:33], v[32:33], v[34:35]
    v_pk_add_f32 v[36:37], v[36:37], v[32:33]
    v_add_f32 v36, v36, v37
    v_add_f32 v37, v38, v39
    v_cndmask_b32 v36, 0, v36, vcc
    v_cndmask_b32 v37, 0, v37, vcc
    s_nop 0
    v_add_f32_dpp v36, v36, v36 quad_perm:[1,0,3,2] row_mask:0xf bank_mask:0xf
    v_add_f32_dpp v37, v37, v37 quad_perm:[1,0,3,2] row_mask:0xf bank_mask:0xf
    s_nop 0
    v_add_f32_dpp v36, v36, v36 quad_perm:[2,3,0,1] row_mask:0xf bank_mask:0xf
    v_add_f32_dpp v37, v37, v37 quad_perm:[2,3,0,1] row_mask:0xf bank_mask:0xf
    s_nop 0
    v_add_f32_dpp v36, v36, v36 row_half_mirror row_mask:0xf bank_mask:0xf
    v_add_f32_dpp v37, v37, v37 row_half_mirror row_mask:0xf bank_mask:0xf
    s_nop 0
    v_add_f32_dpp v36, v36, v36 row_mirror row_mask:0xf bank_mask:0xf
    v_add_f32_dpp v37, v37, v37 row_mirror row_mask:0xf bank_mask:0xf
    s_nop 0
    v_add_f32_dpp v36, v36, v36 row_bcast:15 row_mask:0xa bank_mask:0xf
    v_add_f32_dpp v37, v37, v37 row_bcast:15 row_mask:0xa bank_mask:0xf
    s_nop 0
    v_add_f32_dpp v36, v36, v36 row_bcast:31 row_mask:0xc bank_mask:0xf
    v_add_f32_dpp v37, v37, v37 row_bcast:31 row_mask:0xc bank_mask:0xf
    v_readlane_b32 s77, v36, 63
    v_readlane_b32 s78, v37, 63
    v_mov_b32 v38, 0x3b124925
    v_mul_f32 v36, s77, v38
    v_mul_f32 v37, s78, v38
    v_fma_f32 v37, -v36, v36, v37
    v_add_f32 v36, s79, v36
    v_max_f32 v37, 0, v37
    v_cvt_pk_bf16_f32 v39, v36, v37
    v_lshlrev_b32 v38, 16, v39
    v_and_b32 v39, 0xffff0000, v39
    v_add_f32 v39, 0x3727c5ac, v39
    v_cvt_pk_bf16_f32 v39, v39, v39
    v_lshlrev_b32 v39, 16, v39
    v_sqrt_f32 v39, v39
    s_nop 0
    v_cvt_pk_bf16_f32 v39, v39, v39
    v_lshlrev_b32 v39, 16, v39
    v_rcp_f32 v39, v39
    s_nop 0
    v_pk_add_f32 v[20:21], v[20:21], v[38:39] op_sel_hi:[1,0] neg_lo:[0,1] neg_hi:[0,1]
    v_pk_add_f32 v[22:23], v[22:23], v[38:39] op_sel_hi:[1,0] neg_lo:[0,1] neg_hi:[0,1]
    v_pk_add_f32 v[24:25], v[24:25], v[38:39] op_sel_hi:[1,0] neg_lo:[0,1] neg_hi:[0,1]
    v_pk_add_f32 v[26:27], v[26:27], v[38:39] op_sel_hi:[1,0] neg_lo:[0,1] neg_hi:[0,1]
    v_cvt_pk_bf16_f32 v21, v20, v21
    v_cvt_pk_bf16_f32 v23, v22, v23
    v_cvt_pk_bf16_f32 v25, v24, v25
    v_cvt_pk_bf16_f32 v27, v26, v27
    v_lshlrev_b32 v20, 16, v21
    v_and_b32 v21, 0xffff0000, v21
    v_lshlrev_b32 v22, 16, v23
    v_and_b32 v23, 0xffff0000, v23
    v_lshlrev_b32 v24, 16, v25
    v_and_b32 v25, 0xffff0000, v25
    v_lshlrev_b32 v26, 16, v27
    v_and_b32 v27, 0xffff0000, v27
    v_pk_mul_f32 v[20:21], v[20:21], v[38:39] op_sel:[0,1] op_sel_hi:[1,1]
    v_pk_mul_f32 v[22:23], v[22:23], v[38:39] op_sel:[0,1] op_sel_hi:[1,1]
    v_pk_mul_f32 v[24:25], v[24:25], v[38:39] op_sel:[0,1] op_sel_hi:[1,1]
    v_pk_mul_f32 v[26:27], v[26:27], v[38:39] op_sel:[0,1] op_sel_hi:[1,1]
    v_cvt_pk_bf16_f32 v28, v20, v21
    v_cvt_pk_bf16_f32 v29, v22, v23
    v_cvt_pk_bf16_f32 v30, v24, v25
    v_cvt_pk_bf16_f32 v31, v26, v27
    s_mul_i32 s76, s42, 2080
    v_lshl_add_u32 v10, v0, 4, s76
    ds_write_b128 v10, v[28:31] offset:0
    v_lshlrev_b32 v20, 16, v52
    v_and_b32 v21, 0xffff0000, v52
    v_lshlrev_b32 v22, 16, v53
    v_and_b32 v23, 0xffff0000, v53
    v_lshlrev_b32 v24, 16, v54
    v_and_b32 v25, 0xffff0000, v54
    v_lshlrev_b32 v26, 16, v55
    v_and_b32 v27, 0xffff0000, v55
    v_readlane_b32 s79, v20, 0
    v_cmp_gt_u32 vcc, 56, v0
    s_nop 0
    v_subrev_f32 v28, s79, v20
    v_subrev_f32 v29, s79, v21
    v_subrev_f32 v30, s79, v22
    v_subrev_f32 v31, s79, v23
    v_subrev_f32 v32, s79, v24
    v_subrev_f32 v33, s79, v25
    v_subrev_f32 v34, s79, v26
    v_subrev_f32 v35, s79, v27
    v_pk_mul_f32 v[38:39], v[28:29], v[28:29]
    v_pk_add_f32 v[36:37], v[28:29], v[30:31]
    v_pk_fma_f32 v[38:39], v[30:31], v[30:31], v[38:39]
    v_pk_fma_f32 v[38:39], v[32:33], v[32:33], v[38:39]
    v_pk_fma_f32 v[38:39], v[34:35], v[34:35], v[38:39]
    v_pk_add_f32 v[32:33], v[32:33], v[34:35]
    v_pk_add_f32 v[36:37], v[36:37], v[32:33]
    v_add_f32 v36, v36, v37
    v_add_f32 v37, v38, v39
    v_cndmask_b32 v36, 0, v36, vcc
    v_cndmask_b32 v37, 0, v37, vcc
    s_nop 0
    v_add_f32_dpp v36, v36, v36 quad_perm:[1,0,3,2] row_mask:0xf bank_mask:0xf
    v_add_f32_dpp v37, v37, v37 quad_perm:[1,0,3,2] row_mask:0xf bank_mask:0xf
    s_nop 0
    v_add_f32_dpp v36, v36, v36 quad_perm:[2,3,0,1] row_mask:0xf bank_mask:0xf
    v_add_f32_dpp v37, v37, v37 quad_perm:[2,3,0,1] row_mask:0xf bank_mask:0xf
    s_nop 0
    v_add_f32_dpp v36, v36, v36 row_half_mirror row_mask:0xf bank_mask:0xf
    v_add_f32_dpp v37, v37, v37 row_half_mirror row_mask:0xf bank_mask:0xf
    s_nop 0
    v_add_f32_dpp v36, v36, v36 row_mirror row_mask:0xf bank_mask:0xf
    v_add_f32_dpp v37, v37, v37 row_mirror row_mask:0xf bank_mask:0xf
    s_nop 0
    v_add_f32_dpp v36, v36, v36 row_bcast:15 row_mask:0xa bank_mask:0xf
    v_add_f32_dpp v37, v37, v37 row_bcast:15 row_mask:0xa bank_mask:0xf
    s_nop 0
    v_add_f32_dpp v36, v36, v36 row_bcast:31 row_mask:0xc bank_mask:0xf
    v_add_f32_dpp v37, v37, v37 row_bcast:31 row_mask:0xc bank_mask:0xf
    v_readlane_b32 s77, v36, 63
    v_readlane_b32 s78, v37, 63
    v_mov_b32 v38, 0x3b124925
    v_mul_f32 v36, s77, v38
    v_mul_f32 v37, s78, v38
    v_fma_f32 v37, -v36, v36, v37
    v_add_f32 v36, s79, v36
    v_max_f32 v37, 0, v37
    v_cvt_pk_bf16_f32 v39, v36, v37
    v_lshlrev_b32 v38, 16, v39
    v_and_b32 v39, 0xffff0000, v39
    v_add_f32 v39, 0x3727c5ac, v39
    v_cvt_pk_bf16_f32 v39, v39, v39
    v_lshlrev_b32 v39, 16, v39
    v_sqrt_f32 v39, v39
    s_nop 0
    v_cvt_pk_bf16_f32 v39, v39, v39
    v_lshlrev_b32 v39, 16, v39
    v_rcp_f32 v39, v39
    s_nop 0
    v_pk_add_f32 v[20:21], v[20:21], v[38:39] op_sel_hi:[1,0] neg_lo:[0,1] neg_hi:[0,1]
    v_pk_add_f32 v[22:23], v[22:23], v[38:39] op_sel_hi:[1,0] neg_lo:[0,1] neg_hi:[0,1]
    v_pk_add_f32 v[24:25], v[24:25], v[38:39] op_sel_hi:[1,0] neg_lo:[0,1] neg_hi:[0,1]
    v_pk_add_f32 v[26:27], v[26:27], v[38:39] op_sel_hi:[1,0] neg_lo:[0,1] neg_hi:[0,1]
    v_cvt_pk_bf16_f32 v21, v20, v21
    v_cvt_pk_bf16_f32 v23, v22, v23
    v_cvt_pk_bf16_f32 v25, v24, v25
    v_cvt_pk_bf16_f32 v27, v26, v27
    v_lshlrev_b32 v20, 16, v21
    v_and_b32 v21, 0xffff0000, v21
    v_lshlrev_b32 v22, 16, v23
    v_and_b32 v23, 0xffff0000, v23
    v_lshlrev_b32 v24, 16, v25
    v_and_b32 v25, 0xffff0000, v25
    v_lshlrev_b32 v26, 16, v27
    v_and_b32 v27, 0xffff0000, v27
    v_pk_mul_f32 v[20:21], v[20:21], v[38:39] op_sel:[0,1] op_sel_hi:[1,1]
    v_pk_mul_f32 v[22:23], v[22:23], v[38:39] op_sel:[0,1] op_sel_hi:[1,1]
    v_pk_mul_f32 v[24:25], v[24:25], v[38:39] op_sel:[0,1] op_sel_hi:[1,1]
    v_pk_mul_f32 v[26:27], v[26:27], v[38:39] op_sel:[0,1] op_sel_hi:[1,1]
    v_cvt_pk_bf16_f32 v28, v20, v21
    v_cvt_pk_bf16_f32 v29, v22, v23
    v_cvt_pk_bf16_f32 v30, v24, v25
    v_cvt_pk_bf16_f32 v31, v26, v27
    s_mul_i32 s76, s42, 2080
    v_lshl_add_u32 v10, v0, 4, s76
    ds_write_b128 v10, v[28:31] offset:1040
    s_waitcnt vmcnt(21)
    v_lshrrev_b32 v6, 4, v0
    v_bfe_u32 v7, v0, 2, 2
    v_lshl_add_u32 v6, v6, 3, v7
    v_and_b32 v7, 3, v0
    v_lshlrev_b32 v7, 3, v7
    v_lshl_add_u32 v6, v6, 6, v7
    v_add_u32 v6, s48, v6
    ds_read_b64_tr_b16 v[192:193], v6 offset:24576
    ds_read_b64_tr_b16 v[194:195], v6 offset:24832
    ds_read_b64_tr_b16 v[196:197], v6 offset:26368
    ds_read_b64_tr_b16 v[198:199], v6 offset:26624
    ds_read_b64_tr_b16 v[200:201], v6 offset:28160
    ds_read_b64_tr_b16 v[202:203], v6 offset:28416
    ds_read_b64_tr_b16 v[204:205], v6 offset:29952
    ds_read_b64_tr_b16 v[206:207], v6 offset:30208
    ds_read_b64_tr_b16 v[208:209], v6 offset:24608
    ds_read_b64_tr_b16 v[210:211], v6 offset:24864
    ds_read_b64_tr_b16 v[212:213], v6 offset:26400
    ds_read_b64_tr_b16 v[214:215], v6 offset:26656
    ds_read_b64_tr_b16 v[216:217], v6 offset:28192
    ds_read_b64_tr_b16 v[218:219], v6 offset:28448
    ds_read_b64_tr_b16 v[220:221], v6 offset:29984
    ds_read_b64_tr_b16 v[222:223], v6 offset:30240
    v_and_b32 v10, 7, v0
    v_mul_u32_u24 v10, 1040, v10
    v_and_b32 v11, 48, v0
    s_mul_i32 s76, s42, 224
    v_add3_u32 v10, v10, v11, s76
    s_waitcnt lgkmcnt(0)
    s_barrier
    ds_read2_b64 v[20:23], v10 offset0:0 offset1:1
    ds_read2_b64 v[24:27], v10 offset0:7 offset1:8
    ds_read2_b64 v[28:31], v10 offset0:14 offset1:15
    ds_read2_b64 v[32:35], v10 offset0:21 offset1:22
    s_mov_b32 vcc_lo, -1
    s_mov_b32 vcc_hi, 0x0000ffff
    s_waitcnt lgkmcnt(0)
    v_cndmask_b32 v194, 0, v194, vcc
    v_cndmask_b32 v195, 0, v195, vcc
    v_cndmask_b32 v198, 0, v198, vcc
    v_cndmask_b32 v199, 0, v199, vcc
    v_cndmask_b32 v202, 0, v202, vcc
    v_cndmask_b32 v203, 0, v203, vcc
    v_cndmask_b32 v206, 0, v206, vcc
    v_cndmask_b32 v207, 0, v207, vcc
    v_cndmask_b32 v210, 0, v210, vcc
    v_cndmask_b32 v211, 0, v211, vcc
    v_cndmask_b32 v214, 0, v214, vcc
    v_cndmask_b32 v215, 0, v215, vcc
    v_cndmask_b32 v218, 0, v218, vcc
    v_cndmask_b32 v219, 0, v219, vcc
    v_cndmask_b32 v222, 0, v222, vcc
    v_cndmask_b32 v223, 0, v223, vcc
    v_mfma_f32_16x16x32_bf16 v[36:39], v[20:23], v[192:195], 0
    v_mfma_f32_16x16x32_bf16 v[40:43], v[20:23], v[208:211], 0
    v_mfma_f32_16x16x32_bf16 v[36:39], v[24:27], v[196:199], v[36:39]
    v_mfma_f32_16x16x32_bf16 v[40:43], v[24:27], v[212:215], v[40:43]
    v_mfma_f32_16x16x32_bf16 v[36:39], v[28:31], v[200:203], v[36:39]
    v_mfma_f32_16x16x32_bf16 v[40:43], v[28:31], v[216:219], v[40:43]
    v_mfma_f32_16x16x32_bf16 v[36:39], v[32:35], v[204:207], v[36:39]
    v_mfma_f32_16x16x32_bf16 v[40:43], v[32:35], v[220:223], v[40:43]
    s_lshl_b32 s76, s42, 10
    v_lshl_add_u32 v10, v0, 4, s76
    s_mov_b32 exec_hi, 0
    s_nop 3
    ds_write_b128 v10, v[36:39] offset:14336
    ds_write_b128 v10, v[40:43] offset:14848
    s_mov_b64 exec, -1
    v_bfe_u32 v10, v0, 4, 1
    v_and_b32 v11, 15, v0
    v_lshlrev_b32 v11, 4, v11
    v_lshl_add_u32 v10, v10, 9, v11
    v_lshrrev_b32 v11, 5, v0
    v_lshl_add_u32 v10, v11, 2, v10
    s_lshr_b32 s76, s42, 1
    s_lshl_b32 s76, s76, 8
    s_and_b32 s77, s42, 1
    s_lshl3_add_u32 s76, s77, s76
    s_add_u32 s76, s76, 14336
    v_add_u32 v10, s76, v10
    s_waitcnt lgkmcnt(0)
    s_barrier
    ds_read2st64_b32 v[20:21], v10 offset0:0 offset1:4
    ds_read2st64_b32 v[22:23], v10 offset0:8 offset1:12
    s_lshl_b32 s76, s42, 15
    s_add_u32 s76, s76, s53
    s_add_u32 s76, s76, 0x220000
    v_and_b32 v10, 31, v0
    v_lshlrev_b32 v10, 2, v10
    v_lshl_add_u32 v10, v11, 14, v10
    s_waitcnt lgkmcnt(0)
    v_pk_add_f32 v[20:21], v[20:21], v[22:23]
    v_add_f32 v20, v20, v21
    v_cvt_pk_bf16_f32 v20, v20, v20
    v_lshl_or_b32 v20, v20, 16, 1
    buffer_store_dword v20, v10, s[12:15], s76 offen sc1
    s_waitcnt vmcnt(0)
    s_barrier
    s_cmp_lg_u32 s42, 3
    s_cbranch_scc1 L_sk_5
    s_mul_i32 s76, s27, 6
    s_lshl_b64 s[78:79], 1, s76
    s_or_b32 s79, s79, 0x10000
    v_mov_b32 v62, s78
    v_mov_b32 v63, s79
    s_lshl_b32 s76, s43, 3
    v_mov_b32 v10, s76
    s_mov_b64 exec, 1
    global_atomic_add_x2 v[62:63], v10, v[62:63], s[38:39] sc0 sc1
    s_mov_b64 exec, -1
L_sk_5:
    v_lshlrev_b32 v112, 16, v64
    v_and_b32 v113, 0xffff0000, v64
    v_lshlrev_b32 v140, 16, v78
    v_and_b32 v141, 0xffff0000, v78
    v_lshlrev_b32 v114, 16, v65
    v_and_b32 v115, 0xffff0000, v65
    v_lshlrev_b32 v142, 16, v79
    v_and_b32 v143, 0xffff0000, v79
    v_lshlrev_b32 v116, 16, v66
    v_and_b32 v117, 0xffff0000, v66
    v_lshlrev_b32 v144, 16, v80
    v_and_b32 v145, 0xffff0000, v80
    v_lshlrev_b32 v118, 16, v67
    v_and_b32 v119, 0xffff0000, v67
    v_lshlrev_b32 v146, 16, v81
    v_and_b32 v147, 0xffff0000, v81
    v_lshlrev_b32 v120, 16, v68
    v_and_b32 v121, 0xffff0000, v68
    v_lshlrev_b32 v148, 16, v82
    v_and_b32 v149, 0xffff0000, v82
    v_lshlrev_b32 v122, 16, v69
    v_and_b32 v123, 0xffff0000, v69
    v_lshlrev_b32 v150, 16, v83
    v_and_b32 v151, 0xffff0000, v83
    v_lshlrev_b32 v124, 16, v70
    v_and_b32 v125, 0xffff0000, v70
    v_lshlrev_b32 v152, 16, v84
    v_and_b32 v153, 0xffff0000, v84
    v_lshlrev_b32 v126, 16, v71
    v_and_b32 v127, 0xffff0000, v71
    v_lshlrev_b32 v154, 16, v85
    v_and_b32 v155, 0xffff0000, v85
    v_lshlrev_b32 v128, 16, v72
    v_and_b32 v129, 0xffff0000, v72
    v_lshlrev_b32 v156, 16, v86
    v_and_b32 v157, 0xffff0000, v86
    v_lshlrev_b32 v130, 16, v73
    v_and_b32 v131, 0xffff0000, v73
    v_lshlrev_b32 v158, 16, v87
    v_and_b32 v159, 0xffff0000, v87
    v_lshlrev_b32 v132, 16, v74
    v_and_b32 v133, 0xffff0000, v74
    v_lshlrev_b32 v160, 16, v88
    v_and_b32 v161, 0xffff0000, v88
    v_lshlrev_b32 v134, 16, v75
    v_and_b32 v135, 0xffff0000, v75
    v_lshlrev_b32 v162, 16, v89
    v_and_b32 v163, 0xffff0000, v89
    v_lshlrev_b32 v136, 16, v76
    v_and_b32 v137, 0xffff0000, v76
    v_lshlrev_b32 v164, 16, v90
    v_and_b32 v165, 0xffff0000, v90
    v_lshlrev_b32 v138, 16, v77
    v_and_b32 v139, 0xffff0000, v77
    v_lshlrev_b32 v166, 16, v91
    v_and_b32 v167, 0xffff0000, v91
    s_waitcnt vmcnt(0)
    s_cmp_lg_u32 s42, 3
    s_cbranch_scc1 L_sk_6
    v_readfirstlane_b32 s78, v62
    v_readfirstlane_b32 s79, v63
    s_nop 0
    s_lshr_b32 s76, s79, 16
    s_cmp_eq_u32 s76, 31
    s_nop 0
    s_cbranch_scc0 L_sk_6
    s_mul_i32 s76, s27, 6
    s_lshr_b64 s[78:79], s[78:79], s76
    s_and_b32 s76, s78, 63
    s_cmp_eq_u32 s76, 31
    s_cselect_b32 s76, 3, 2
    v_mov_b32 v11, s76
    s_lshl_b32 s76, s43, 2
    v_mov_b32 v10, s76
    s_mov_b64 exec, 1
    global_store_dword v10, v11, s[38:39] offset:128 sc1
    s_mov_b64 exec, -1
L_sk_6:
    s_branch L_bfirst
L_main:
    s_cmp_lg_u32 s72, 0
    s_cbranch_scc1 L_fast_8
L_slow_7:
    buffer_load_dword v10, off, s[12:15], s70 sc1
    s_add_u32 s76, s71, 2
    s_min_u32 s76, s76, 32
    s_mov_b32 s89, s76
    s_call_b64 s[74:75], L_pieces
    s_sub_u32 s56, s56, 1
    s_cbranch_scc1 L_exit
    s_waitcnt vmcnt(0)
    v_readfirstlane_b32 s76, v10
    s_nop 0
    s_cmp_lt_u32 s76, s54
    s_nop 1
    s_cbranch_scc1 L_slow_7
L_fast_8:
    s_mov_b32 s89, 32
    s_call_b64 s[74:75], L_pieces
    s_waitcnt vmcnt(16)
L_fast2:
    v_xor_b32 v6, 64, v4
    v_xor_b32 v7, 128, v4
    v_xor_b32 v8, 192, v4
    ds_read_b128 a[0:3], v4 offset:0
    ds_read_b128 a[4:7], v6 offset:0
    ds_read_b128 a[8:11], v7 offset:0
    ds_read_b128 a[12:15], v8 offset:0
    ds_read_b128 a[16:19], v4 offset:256
    ds_read_b128 a[20:23], v6 offset:256
    ds_read_b128 a[24:27], v7 offset:256
    ds_read_b128 a[28:31], v8 offset:256
    v_xor_b32 v6, 64, v4
    v_xor_b32 v7, 128, v4
    v_xor_b32 v8, 192, v4
    ds_read_b128 a[32:35], v4 offset:8192
    ds_read_b128 a[36:39], v6 offset:8192
    ds_read_b128 a[40:43], v7 offset:8192
    ds_read_b128 a[44:47], v8 offset:8192
    ds_read_b128 a[48:51], v4 offset:8448
    ds_read_b128 a[52:55], v6 offset:8448
    ds_read_b128 a[56:59], v7 offset:8448
    ds_read_b128 a[60:63], v8 offset:8448
    s_waitcnt lgkmcnt(0)
    s_add_u32 m0, s48, 0
    v_xor_b32 v3, 0x20000, v1
    buffer_load_dwordx4 v3, s[4:7], s47 offen nt lds
    s_add_u32 m0, s48, 1024
    v_xor_b32 v3, 0x21020, v1
    buffer_load_dwordx4 v3, s[4:7], s47 offen nt lds
    s_add_u32 m0, s48, 2048
    v_xor_b32 v3, 0x22040, v1
    buffer_load_dwordx4 v3, s[4:7], s47 offen nt lds
    s_add_u32 m0, s48, 3072
    v_xor_b32 v3, 0x23060, v1
    buffer_load_dwordx4 v3, s[4:7], s47 offen nt lds
    s_waitcnt vmcnt(12)
    v_xor_b32 v6, 64, v4
    v_xor_b32 v7, 128, v4
    v_xor_b32 v8, 192, v4
    ds_read_b128 a[64:67], v4 offset:16384
    ds_read_b128 a[68:71], v6 offset:16384
    ds_read_b128 a[72:75], v7 offset:16384
    ds_read_b128 a[76:79], v8 offset:16384
    ds_read_b128 a[80:83], v4 offset:16640
    ds_read_b128 a[84:87], v6 offset:16640
    ds_read_b128 a[88:91], v7 offset:16640
    ds_read_b128 a[92:95], v8 offset:16640
    s_waitcnt lgkmcnt(0)
    s_add_u32 m0, s48, 4096
    v_xor_b32 v3, 0x24080, v1
    buffer_load_dwordx4 v3, s[4:7], s47 offen nt lds
    s_add_u32 m0, s48, 5120
    v_xor_b32 v3, 0x250a0, v1
    buffer_load_dwordx4 v3, s[4:7], s47 offen nt lds
    s_add_u32 m0, s48, 6144
    v_xor_b32 v3, 0x260c0, v1
    buffer_load_dwordx4 v3, s[4:7], s47 offen nt lds
    s_add_u32 m0, s48, 7168
    v_xor_b32 v3, 0x270e0, v1
    buffer_load_dwordx4 v3, s[4:7], s47 offen nt lds
    s_add_u32 m0, s48, 8192
    v_xor_b32 v3, 0x28000, v1
    buffer_load_dwordx4 v3, s[4:7], s47 offen nt lds
    s_add_u32 m0, s48, 9216
    v_xor_b32 v3, 0x29020, v1
    buffer_load_dwordx4 v3, s[4:7], s47 offen nt lds
    s_add_u32 m0, s48, 10240
    v_xor_b32 v3, 0x2a040, v1
    buffer_load_dwordx4 v3, s[4:7], s47 offen nt lds
    s_add_u32 m0, s48, 11264
    v_xor_b32 v3, 0x2b060, v1
    buffer_load_dwordx4 v3, s[4:7], s47 offen nt lds
    s_add_u32 m0, s48, 12288
    v_xor_b32 v3, 0x2c080, v1
    buffer_load_dwordx4 v3, s[4:7], s47 offen nt lds
    s_add_u32 m0, s48, 13312
    v_xor_b32 v3, 0x2d0a0, v1
    buffer_load_dwordx4 v3, s[4:7], s47 offen nt lds
    s_add_u32 m0, s48, 14336
    v_xor_b32 v3, 0x2e0c0, v1
    buffer_load_dwordx4 v3, s[4:7], s47 offen nt lds
    s_add_u32 m0, s48, 15360
    v_xor_b32 v3, 0x2f0e0, v1
    buffer_load_dwordx4 v3, s[4:7], s47 offen nt lds
L_mid:
    s_waitcnt vmcnt(16)
    v_xor_b32 v6, 64, v4
    v_xor_b32 v7, 128, v4
    v_xor_b32 v8, 192, v4
    ds_read_b128 a[96:99], v4 offset:24576
    ds_read_b128 a[100:103], v6 offset:24576
    ds_read_b128 a[104:107], v7 offset:24576
    ds_read_b128 a[108:111], v8 offset:24576
    ds_read_b128 a[112:115], v4 offset:24832
    ds_read_b128 a[116:119], v6 offset:24832
    ds_read_b128 a[120:123], v7 offset:24832
    ds_read_b128 a[124:127], v8 offset:24832
    s_waitcnt lgkmcnt(0)
    s_add_u32 m0, s48, 16384
    v_xor_b32 v3, 0x30000, v1
    buffer_load_dwordx4 v3, s[4:7], s47 offen nt lds
    s_add_u32 m0, s48, 17408
    v_xor_b32 v3, 0x31020, v1
    buffer_load_dwordx4 v3, s[4:7], s47 offen nt lds
    s_add_u32 m0, s48, 18432
    v_xor_b32 v3, 0x32040, v1
    buffer_load_dwordx4 v3, s[4:7], s47 offen nt lds
    s_add_u32 m0, s48, 19456
    v_xor_b32 v3, 0x33060, v1
    buffer_load_dwordx4 v3, s[4:7], s47 offen nt lds
    s_waitcnt vmcnt(12)
    s_lshl_b32 s77, s43, 2
    v_mov_b32 v10, s77
    global_load_dword v60, v10, s[38:39] offset:128 sc1
    v_xor_b32 v6, 64, v4
    v_xor_b32 v7, 128, v4
    v_xor_b32 v8, 192, v4
    ds_read_b128 a[128:131], v4 offset:0
    ds_read_b128 a[132:135], v6 offset:0
    ds_read_b128 a[136:139], v7 offset:0
    ds_read_b128 a[140:143], v8 offset:0
    ds_read_b128 a[144:147], v4 offset:256
    ds_read_b128 a[148:151], v6 offset:256
    ds_read_b128 a[152:155], v7 offset:256
    ds_read_b128 a[156:159], v8 offset:256
    s_waitcnt lgkmcnt(0)
    s_add_u32 m0, s48, 20480
    v_xor_b32 v3, 0x34080, v1
    buffer_load_dwordx4 v3, s[4:7], s47 offen nt lds
    s_add_u32 m0, s48, 21504
    v_xor_b32 v3, 0x350a0, v1
    buffer_load_dwordx4 v3, s[4:7], s47 offen nt lds
    s_add_u32 m0, s48, 22528
    v_xor_b32 v3, 0x360c0, v1
    buffer_load_dwordx4 v3, s[4:7], s47 offen nt lds
    s_add_u32 m0, s48, 23552
    v_xor_b32 v3, 0x370e0, v1
    buffer_load_dwordx4 v3, s[4:7], s47 offen nt lds
    s_add_u32 m0, s48, 24576
    v_xor_b32 v3, 0x38000, v1
    buffer_load_dwordx4 v3, s[4:7], s47 offen nt lds
    s_add_u32 m0, s48, 25600
    v_xor_b32 v3, 0x39020, v1
    buffer_load_dwordx4 v3, s[4:7], s47 offen nt lds
    s_add_u32 m0, s48, 26624
    v_xor_b32 v3, 0x3a040, v1
    buffer_load_dwordx4 v3, s[4:7], s47 offen nt lds
    s_add_u32 m0, s48, 27648
    v_xor_b32 v3, 0x3b060, v1
    buffer_load_dwordx4 v3, s[4:7], s47 offen nt lds
    s_waitcnt vmcnt(12)
    v_xor_b32 v6, 64, v4
    v_xor_b32 v7, 128, v4
    v_xor_b32 v8, 192, v4
    ds_read_b128 a[160:163], v4 offset:8192
    ds_read_b128 a[164:167], v6 offset:8192
    ds_read_b128 a[168:171], v7 offset:8192
    ds_read_b128 a[172:175], v8 offset:8192
    ds_read_b128 a[176:179], v4 offset:8448
    ds_read_b128 a[180:183], v6 offset:8448
    ds_read_b128 a[184:187], v7 offset:8448
    ds_read_b128 a[188:191], v8 offset:8448
    s_waitcnt lgkmcnt(0)
    s_add_u32 m0, s48, 28672
    v_xor_b32 v3, 0x3c080, v1
    buffer_load_dwordx4 v3, s[4:7], s47 offen nt lds
    s_add_u32 m0, s48, 29696
    v_xor_b32 v3, 0x3d0a0, v1
    buffer_load_dwordx4 v3, s[4:7], s47 offen nt lds
    s_add_u32 m0, s48, 30720
    v_xor_b32 v3, 0x3e0c0, v1
    buffer_load_dwordx4 v3, s[4:7], s47 offen nt lds
    s_add_u32 m0, s48, 31744
    v_xor_b32 v3, 0x3f0e0, v1
    buffer_load_dwordx4 v3, s[4:7], s47 offen nt lds
    s_add_u32 m0, s48, 0
    v_xor_b32 v3, 0x0, v2
    buffer_load_dwordx4 v3, s[8:11], s47 offen nt lds
    s_add_u32 m0, s48, 1024
    v_xor_b32 v3, 0x1080, v2
    buffer_load_dwordx4 v3, s[8:11], s47 offen nt lds
    s_add_u32 m0, s48, 2048
    v_xor_b32 v3, 0x2100, v2
    buffer_load_dwordx4 v3, s[8:11], s47 offen nt lds
    s_add_u32 m0, s48, 3072
    v_xor_b32 v3, 0x3180, v2
    buffer_load_dwordx4 v3, s[8:11], s47 offen nt lds
    s_waitcnt vmcnt(12)
    s_cmp_lg_u32 s54, 0
    s_cbranch_scc1 L_n_9
    s_call_b64 s[62:63], L_gochk
L_n_9:
    s_lshl_b32 s76, s54, 14
    s_add_u32 s76, s76, 0x220000
    s_lshl_b32 s77, s43, 11
    s_add_u32 s76, s76, s77
    v_lshlrev_b32 v10, 4, v0
    buffer_load_dwordx4 v[44:47], v10, s[12:15], s76 offen sc1
    buffer_load_dwordx4 v[48:51], v10, s[12:15], s76 offen offset:1024 sc1
    v_xor_b32 v6, 64, v4
    v_xor_b32 v7, 128, v4
    v_xor_b32 v8, 192, v4
    ds_read_b128 a[192:195], v4 offset:16384
    ds_read_b128 a[196:199], v6 offset:16384
    ds_read_b128 a[200:203], v7 offset:16384
    ds_read_b128 a[204:207], v8 offset:16384
    ds_read_b128 a[208:211], v4 offset:16640
    ds_read_b128 a[212:215], v6 offset:16640
    ds_read_b128 a[216:219], v7 offset:16640
    ds_read_b128 a[220:223], v8 offset:16640
    s_waitcnt lgkmcnt(0)
    s_add_u32 m0, s48, 4096
    v_xor_b32 v3, 0x4200, v2
    buffer_load_dwordx4 v3, s[8:11], s47 offen nt lds
    s_add_u32 m0, s48, 5120
    v_xor_b32 v3, 0x5280, v2
    buffer_load_dwordx4 v3, s[8:11], s47 offen nt lds
    s_add_u32 m0, s48, 6144
    v_xor_b32 v3, 0x6300, v2
    buffer_load_dwordx4 v3, s[8:11], s47 offen nt lds
    s_add_u32 m0, s48, 7168
    v_xor_b32 v3, 0x7380, v2
    buffer_load_dwordx4 v3, s[8:11], s47 offen nt lds
    s_add_u32 m0, s48, 8192
    v_xor_b32 v3, 0x8000, v2
    buffer_load_dwordx4 v3, s[8:11], s47 offen nt lds
    s_add_u32 m0, s48, 9216
    v_xor_b32 v3, 0x9080, v2
    buffer_load_dwordx4 v3, s[8:11], s47 offen nt lds
    s_add_u32 m0, s48, 10240
    v_xor_b32 v3, 0xa100, v2
    buffer_load_dwordx4 v3, s[8:11], s47 offen nt lds
    s_add_u32 m0, s48, 11264
    v_xor_b32 v3, 0xb180, v2
    buffer_load_dwordx4 v3, s[8:11], s47 offen nt lds
    s_waitcnt vmcnt(12)
    v_xor_b32 v6, 64, v4
    v_xor_b32 v7, 128, v4
    v_xor_b32 v8, 192, v4
    ds_read_b128 a[224:227], v4 offset:24576
    ds_read_b128 a[228:231], v6 offset:24576
    ds_read_b128 a[232:235], v7 offset:24576
    ds_read_b128 a[236:239], v8 offset:24576
    ds_read_b128 a[240:243], v4 offset:24832
    ds_read_b128 a[244:247], v6 offset:24832
    ds_read_b128 a[248:251], v7 offset:24832
    ds_read_b128 a[252:255], v8 offset:24832
    s_waitcnt lgkmcnt(0)
    s_add_u32 m0, s48, 12288
    v_xor_b32 v3, 0xc200, v2
    buffer_load_dwordx4 v3, s[8:11], s47 offen nt lds
    s_add_u32 m0, s48, 13312
    v_xor_b32 v3, 0xd280, v2
    buffer_load_dwordx4 v3, s[8:11], s47 offen nt lds
    s_add_u32 m0, s48, 14336
    v_xor_b32 v3, 0xe300, v2
    buffer_load_dwordx4 v3, s[8:11], s47 offen nt lds
    s_add_u32 m0, s48, 15360
    v_xor_b32 v3, 0xf380, v2
    buffer_load_dwordx4 v3, s[8:11], s47 offen nt lds
    s_add_u32 m0, s48, 16384
    v_xor_b32 v3, 0x10000, v2
    buffer_load_dwordx4 v3, s[8:11], s47 offen nt lds
    s_add_u32 m0, s48, 17408
    v_xor_b32 v3, 0x11080, v2
    buffer_load_dwordx4 v3, s[8:11], s47 offen nt lds
    s_add_u32 m0, s48, 18432
    v_xor_b32 v3, 0x12100, v2
    buffer_load_dwordx4 v3, s[8:11], s47 offen nt lds
    s_add_u32 m0, s48, 19456
    v_xor_b32 v3, 0x13180, v2
    buffer_load_dwordx4 v3, s[8:11], s47 offen nt lds
    s_waitcnt vmcnt(12)
    v_xor_b32 v6, 128, v5
    v_xor_b32 v7, 0x240, v5
    v_xor_b32 v8, 0x2c0, v5
    ds_read_b64_tr_b16 v[64:65], v5 offset:0
    ds_read_b64_tr_b16 v[66:67], v6 offset:0
    ds_read_b64_tr_b16 v[68:69], v5 offset:256
    ds_read_b64_tr_b16 v[70:71], v6 offset:256
    ds_read_b64_tr_b16 v[72:73], v5 offset:2304
    ds_read_b64_tr_b16 v[74:75], v6 offset:2304
    ds_read_b64_tr_b16 v[76:77], v5 offset:2048
    ds_read_b64_tr_b16 v[78:79], v6 offset:2048
    ds_read_b64_tr_b16 v[80:81], v7 offset:4096
    ds_read_b64_tr_b16 v[82:83], v8 offset:4096
    ds_read_b64_tr_b16 v[84:85], v7 offset:4352
    ds_read_b64_tr_b16 v[86:87], v8 offset:4352
    ds_read_b64_tr_b16 v[88:89], v7 offset:6400
    ds_read_b64_tr_b16 v[90:91], v8 offset:6400
    ds_read_b64_tr_b16 v[92:93], v7 offset:6144
    ds_read_b64_tr_b16 v[94:95], v8 offset:6144
    s_waitcnt lgkmcnt(0)
    s_mov_b32 s77, 0x07060302
    v_perm_b32 v52, v45, v44, s77
    v_perm_b32 v53, v47, v46, s77
    v_perm_b32 v54, v49, v48, s77
    v_perm_b32 v55, v51, v50, s77
    s_lshl_b32 s76, s42, 10
    v_lshl_add_u32 v10, v0, 3, s76
    ds_write_b64 v10, v[52:53] offset:22528
    ds_write_b64 v10, v[54:55] offset:23040
    v_and_b32 v9, 1, v0
    v_and_b32 v3, 48, v0
    v_lshl_add_u32 v9, v9, 9, v3
    v_add_u32 v9, s76, v9
    ds_read_b128 v[224:227], v9 offset:22528
    ds_read_b128 v[228:231], v9 offset:22592
    ds_read_b128 v[232:235], v9 offset:22656
    ds_read_b128 v[236:239], v9 offset:22720
    ds_read_b128 v[240:243], v9 offset:22784
    ds_read_b128 v[244:247], v9 offset:22848
    ds_read_b128 v[248:251], v9 offset:22912
    ds_read_b128 v[252:255], v9 offset:22976
    s_waitcnt lgkmcnt(0)
    v_mfma_f32_16x16x32_bf16 v[12:15], a[0:3], v[224:227], 0
    v_mfma_f32_16x16x32_bf16 v[12:15], a[4:7], v[228:231], v[12:15]
    v_mfma_f32_16x16x32_bf16 v[12:15], a[8:11], v[232:235], v[12:15]
    v_mfma_f32_16x16x32_bf16 v[12:15], a[12:15], v[236:239], v[12:15]
    v_mfma_f32_16x16x32_bf16 v[12:15], a[16:19], v[240:243], v[12:15]
    s_add_u32 m0, s48, 20480
    v_xor_b32 v3, 0x14200, v2
    buffer_load_dwordx4 v3, s[8:11], s47 offen nt lds
    v_mfma_f32_16x16x32_bf16 v[12:15], a[20:23], v[244:247], v[12:15]
    v_mfma_f32_16x16x32_bf16 v[12:15], a[24:27], v[248:251], v[12:15]
    v_mfma_f32_16x16x32_bf16 v[12:15], a[28:31], v[252:255], v[12:15]
    v_mfma_f32_16x16x32_bf16 v[16:19], a[32:35], v[224:227], 0
    v_mfma_f32_16x16x32_bf16 v[16:19], a[36:39], v[228:231], v[16:19]
    v_mfma_f32_16x16x32_bf16 v[16:19], a[40:43], v[232:235], v[16:19]
    v_mfma_f32_16x16x32_bf16 v[16:19], a[44:47], v[236:239], v[16:19]
    v_mfma_f32_16x16x32_bf16 v[16:19], a[48:51], v[240:243], v[16:19]
    v_mfma_f32_16x16x32_bf16 v[16:19], a[52:55], v[244:247], v[16:19]
    v_mfma_f32_16x16x32_bf16 v[16:19], a[56:59], v[248:251], v[16:19]
    s_add_u32 m0, s48, 21504
    v_xor_b32 v3, 0x15280, v2
    buffer_load_dwordx4 v3, s[8:11], s47 offen nt lds
    v_mfma_f32_16x16x32_bf16 v[16:19], a[60:63], v[252:255], v[16:19]
    v_mfma_f32_16x16x32_bf16 v[20:23], a[64:67], v[224:227], 0
    v_mfma_f32_16x16x32_bf16 v[20:23], a[68:71], v[228:231], v[20:23]
    v_mfma_f32_16x16x32_bf16 v[20:23], a[72:75], v[232:235], v[20:23]
    v_mfma_f32_16x16x32_bf16 v[20:23], a[76:79], v[236:239], v[20:23]
    v_mfma_f32_16x16x32_bf16 v[20:23], a[80:83], v[240:243], v[20:23]
    v_mfma_f32_16x16x32_bf16 v[20:23], a[84:87], v[244:247], v[20:23]
    v_mfma_f32_16x16x32_bf16 v[20:23], a[88:91], v[248:251], v[20:23]
    v_mfma_f32_16x16x32_bf16 v[20:23], a[92:95], v[252:255], v[20:23]
    v_mfma_f32_16x16x32_bf16 v[24:27], a[96:99], v[224:227], 0
    s_add_u32 m0, s48, 22528
    v_xor_b32 v3, 0x16300, v2
    buffer_load_dwordx4 v3, s[8:11], s47 offen nt lds
    v_mfma_f32_16x16x32_bf16 v[24:27], a[100:103], v[228:231], v[24:27]
    v_mfma_f32_16x16x32_bf16 v[24:27], a[104:107], v[232:235], v[24:27]
    v_mfma_f32_16x16x32_bf16 v[24:27], a[108:111], v[236:239], v[24:27]
    v_mfma_f32_16x16x32_bf16 v[24:27], a[112:115], v[240:243], v[24:27]
    v_mfma_f32_16x16x32_bf16 v[24:27], a[116:119], v[244:247], v[24:27]
    v_mfma_f32_16x16x32_bf16 v[24:27], a[120:123], v[248:251], v[24:27]
    v_mfma_f32_16x16x32_bf16 v[24:27], a[124:127], v[252:255], v[24:27]
    v_mfma_f32_16x16x32_bf16 v[28:31], a[128:131], v[224:227], 0
    v_mfma_f32_16x16x32_bf16 v[28:31], a[132:135], v[228:231], v[28:31]
    v_mfma_f32_16x16x32_bf16 v[28:31], a[136:139], v[232:235], v[28:31]
    s_add_u32 m0, s48, 23552
    v_xor_b32 v3, 0x17380, v2
    buffer_load_dwordx4 v3, s[8:11], s47 offen nt lds
    v_mfma_f32_16x16x32_bf16 v[28:31], a[140:143], v[236:239], v[28:31]
    v_mfma_f32_16x16x32_bf16 v[28:31], a[144:147], v[240:243], v[28:31]
    v_mfma_f32_16x16x32_bf16 v[28:31], a[148:151], v[244:247], v[28:31]
    v_mfma_f32_16x16x32_bf16 v[28:31], a[152:155], v[248:251], v[28:31]
    v_mfma_f32_16x16x32_bf16 v[28:31], a[156:159], v[252:255], v[28:31]
    v_mfma_f32_16x16x32_bf16 v[32:35], a[160:163], v[224:227], 0
    v_mfma_f32_16x16x32_bf16 v[32:35], a[164:167], v[228:231], v[32:35]
    v_mfma_f32_16x16x32_bf16 v[32:35], a[168:171], v[232:235], v[32:35]
    v_mfma_f32_16x16x32_bf16 v[32:35], a[172:175], v[236:239], v[32:35]
    v_mfma_f32_16x16x32_bf16 v[32:35], a[176:179], v[240:243], v[32:35]
    s_add_u32 m0, s48, 24576
    v_xor_b32 v3, 0x18000, v2
    buffer_load_dwordx4 v3, s[8:11], s47 offen nt lds
    v_mfma_f32_16x16x32_bf16 v[32:35], a[180:183], v[244:247], v[32:35]
    v_mfma_f32_16x16x32_bf16 v[32:35], a[184:187], v[248:251], v[32:35]
    v_mfma_f32_16x16x32_bf16 v[32:35], a[188:191], v[252:255], v[32:35]
    v_mfma_f32_16x16x32_bf16 v[36:39], a[192:195], v[224:227], 0
    v_mfma_f32_16x16x32_bf16 v[36:39], a[196:199], v[228:231], v[36:39]
    v_mfma_f32_16x16x32_bf16 v[36:39], a[200:203], v[232:235], v[36:39]
    v_mfma_f32_16x16x32_bf16 v[36:39], a[204:207], v[236:239], v[36:39]
    v_mfma_f32_16x16x32_bf16 v[36:39], a[208:211], v[240:243], v[36:39]
    v_mfma_f32_16x16x32_bf16 v[36:39], a[212:215], v[244:247], v[36:39]
    v_mfma_f32_16x16x32_bf16 v[36:39], a[216:219], v[248:251], v[36:39]
    s_add_u32 m0, s48, 25600
    v_xor_b32 v3, 0x19080, v2
    buffer_load_dwordx4 v3, s[8:11], s47 offen nt lds
    v_mfma_f32_16x16x32_bf16 v[36:39], a[220:223], v[252:255], v[36:39]
    v_mfma_f32_16x16x32_bf16 v[40:43], a[224:227], v[224:227], 0
    v_mfma_f32_16x16x32_bf16 v[40:43], a[228:231], v[228:231], v[40:43]
    v_mfma_f32_16x16x32_bf16 v[40:43], a[232:235], v[232:235], v[40:43]
    v_mfma_f32_16x16x32_bf16 v[40:43], a[236:239], v[236:239], v[40:43]
    v_mfma_f32_16x16x32_bf16 v[40:43], a[240:243], v[240:243], v[40:43]
    v_mfma_f32_16x16x32_bf16 v[40:43], a[244:247], v[244:247], v[40:43]
    v_mfma_f32_16x16x32_bf16 v[40:43], a[248:251], v[248:251], v[40:43]
    v_mfma_f32_16x16x32_bf16 v[40:43], a[252:255], v[252:255], v[40:43]
    s_add_u32 m0, s48, 26624
    v_xor_b32 v3, 0x1a100, v2
    buffer_load_dwordx4 v3, s[8:11], s47 offen nt lds
    s_add_u32 m0, s48, 27648
    v_xor_b32 v3, 0x1b180, v2
    buffer_load_dwordx4 v3, s[8:11], s47 offen nt lds
    s_waitcnt vmcnt(12)
    v_xor_b32 v6, 128, v5
    v_xor_b32 v7, 0x240, v5
    v_xor_b32 v8, 0x2c0, v5
    ds_read_b64_tr_b16 v[96:97], v5 offset:8192
    ds_read_b64_tr_b16 v[98:99], v6 offset:8192
    ds_read_b64_tr_b16 v[100:101], v5 offset:8448
    ds_read_b64_tr_b16 v[102:103], v6 offset:8448
    ds_read_b64_tr_b16 v[104:105], v5 offset:10496
    ds_read_b64_tr_b16 v[106:107], v6 offset:10496
    ds_read_b64_tr_b16 v[108:109], v5 offset:10240
    ds_read_b64_tr_b16 v[110:111], v6 offset:10240
    ds_read_b64_tr_b16 v[112:113], v7 offset:12288
    ds_read_b64_tr_b16 v[114:115], v8 offset:12288
    ds_read_b64_tr_b16 v[116:117], v7 offset:12544
    ds_read_b64_tr_b16 v[118:119], v8 offset:12544
    ds_read_b64_tr_b16 v[120:121], v7 offset:14592
    ds_read_b64_tr_b16 v[122:123], v8 offset:14592
    ds_read_b64_tr_b16 v[124:125], v7 offset:14336
    ds_read_b64_tr_b16 v[126:127], v8 offset:14336
    s_waitcnt lgkmcnt(0)
    v_max3_f32 v10, v12, v13, v14
    v_max3_f32 v11, v15, v16, v17
    v_max3_f32 v10, v10, v18, v19
    v_max3_f32 v11, v11, v20, v21
    v_max3_f32 v10, v10, v22, v23
    v_max3_f32 v11, v11, v24, v25
    v_max3_f32 v10, v10, v26, v27
    v_max3_f32 v11, v11, v28, v29
    v_max3_f32 v10, v10, v30, v31
    v_max3_f32 v11, v11, v32, v33
    v_max3_f32 v10, v10, v34, v35
    v_max3_f32 v11, v11, v36, v37
    v_max3_f32 v10, v10, v38, v39
    v_max3_f32 v11, v11, v40, v41
    v_max3_f32 v10, v10, v42, v43
    v_max_f32 v10, v10, v11
    v_mov_b32 v11, v10
    s_nop 1
    v_permlane16_swap_b32 v10, v11
    s_add_u32 m0, s48, 28672
    v_xor_b32 v3, 0x1c200, v2
    buffer_load_dwordx4 v3, s[8:11], s47 offen nt lds
    v_max_f32 v10, v10, v11
    v_mov_b32 v11, v10
    s_nop 1
    v_permlane32_swap_b32 v10, v11
    v_max_f32 v10, v10, v11
    v_mul_f32 v10, s58, v10
    v_mov_b32 v60, s58
    v_pk_fma_f32 v[12:13], v[12:13], v[60:61], v[10:11] op_sel_hi:[1,0,0] neg_lo:[0,0,1] neg_hi:[0,0,1]
    v_pk_fma_f32 v[14:15], v[14:15], v[60:61], v[10:11] op_sel_hi:[1,0,0] neg_lo:[0,0,1] neg_hi:[0,0,1]
    v_pk_fma_f32 v[16:17], v[16:17], v[60:61], v[10:11] op_sel_hi:[1,0,0] neg_lo:[0,0,1] neg_hi:[0,0,1]
    v_pk_fma_f32 v[18:19], v[18:19], v[60:61], v[10:11] op_sel_hi:[1,0,0] neg_lo:[0,0,1] neg_hi:[0,0,1]
    v_pk_fma_f32 v[20:21], v[20:21], v[60:61], v[10:11] op_sel_hi:[1,0,0] neg_lo:[0,0,1] neg_hi:[0,0,1]
    v_pk_fma_f32 v[22:23], v[22:23], v[60:61], v[10:11] op_sel_hi:[1,0,0] neg_lo:[0,0,1] neg_hi:[0,0,1]
    v_pk_fma_f32 v[24:25], v[24:25], v[60:61], v[10:11] op_sel_hi:[1,0,0] neg_lo:[0,0,1] neg_hi:[0,0,1]
    v_pk_fma_f32 v[26:27], v[26:27], v[60:61], v[10:11] op_sel_hi:[1,0,0] neg_lo:[0,0,1] neg_hi:[0,0,1]
    v_pk_fma_f32 v[28:29], v[28:29], v[60:61], v[10:11] op_sel_hi:[1,0,0] neg_lo:[0,0,1] neg_hi:[0,0,1]
    v_pk_fma_f32 v[30:31], v[30:31], v[60:61], v[10:11] op_sel_hi:[1,0,0] neg_lo:[0,0,1] neg_hi:[0,0,1]
    v_pk_fma_f32 v[32:33], v[32:33], v[60:61], v[10:11] op_sel_hi:[1,0,0] neg_lo:[0,0,1] neg_hi:[0,0,1]
    v_pk_fma_f32 v[34:35], v[34:35], v[60:61], v[10:11] op_sel_hi:[1,0,0] neg_lo:[0,0,1] neg_hi:[0,0,1]
    v_pk_fma_f32 v[36:37], v[36:37], v[60:61], v[10:11] op_sel_hi:[1,0,0] neg_lo:[0,0,1] neg_hi:[0,0,1]
    v_pk_fma_f32 v[38:39], v[38:39], v[60:61], v[10:11] op_sel_hi:[1,0,0] neg_lo:[0,0,1] neg_hi:[0,0,1]
    v_pk_fma_f32 v[40:41], v[40:41], v[60:61], v[10:11] op_sel_hi:[1,0,0] neg_lo:[0,0,1] neg_hi:[0,0,1]
    v_pk_fma_f32 v[42:43], v[42:43], v[60:61], v[10:11] op_sel_hi:[1,0,0] neg_lo:[0,0,1] neg_hi:[0,0,1]
    v_exp_f32 v12, v12
    v_exp_f32 v13, v13
    v_exp_f32 v14, v14
    v_exp_f32 v15, v15
    v_exp_f32 v16, v16
    v_exp_f32 v17, v17
    v_exp_f32 v18, v18
    v_exp_f32 v19, v19
    s_add_u32 m0, s48, 29696
    v_xor_b32 v3, 0x1d280, v2
    buffer_load_dwordx4 v3, s[8:11], s47 offen nt lds
    v_exp_f32 v20, v20
    v_exp_f32 v21, v21
    v_exp_f32 v22, v22
    v_exp_f32 v23, v23
    v_exp_f32 v24, v24
    v_exp_f32 v25, v25
    v_exp_f32 v26, v26
    v_exp_f32 v27, v27
    v_exp_f32 v28, v28
    v_exp_f32 v29, v29
    v_exp_f32 v30, v30
    v_exp_f32 v31, v31
    v_exp_f32 v32, v32
    v_exp_f32 v33, v33
    v_exp_f32 v34, v34
    v_exp_f32 v35, v35
    v_exp_f32 v36, v36
    v_exp_f32 v37, v37
    v_exp_f32 v38, v38
    s_add_u32 m0, s48, 30720
    v_xor_b32 v3, 0x1e300, v2
    buffer_load_dwordx4 v3, s[8:11], s47 offen nt lds
    v_exp_f32 v39, v39
    v_exp_f32 v40, v40
    v_exp_f32 v41, v41
    v_exp_f32 v42, v42
    v_exp_f32 v43, v43
    v_cvt_pk_bf16_f32 v44, v12, v13
    v_cvt_pk_bf16_f32 v45, v14, v15
    v_cvt_pk_bf16_f32 v46, v16, v17
    v_cvt_pk_bf16_f32 v47, v18, v19
    v_cvt_pk_bf16_f32 v48, v20, v21
    v_cvt_pk_bf16_f32 v49, v22, v23
    v_cvt_pk_bf16_f32 v50, v24, v25
    v_cvt_pk_bf16_f32 v51, v26, v27
    v_cvt_pk_bf16_f32 v52, v28, v29
    v_cvt_pk_bf16_f32 v53, v30, v31
    v_cvt_pk_bf16_f32 v54, v32, v33
    v_cvt_pk_bf16_f32 v55, v34, v35
    v_cvt_pk_bf16_f32 v56, v36, v37
    v_cvt_pk_bf16_f32 v57, v38, v39
    v_cvt_pk_bf16_f32 v58, v40, v41
    v_cvt_pk_bf16_f32 v59, v42, v43
    v_pk_add_f32 v[12:13], v[12:13], v[28:29]
    v_pk_add_f32 v[14:15], v[14:15], v[30:31]
    v_pk_add_f32 v[16:17], v[16:17], v[32:33]
    v_pk_add_f32 v[18:19], v[18:19], v[34:35]
    v_pk_add_f32 v[20:21], v[20:21], v[36:37]
    v_pk_add_f32 v[22:23], v[22:23], v[38:39]
    v_pk_add_f32 v[24:25], v[24:25], v[40:41]
    v_pk_add_f32 v[26:27], v[26:27], v[42:43]
    v_pk_add_f32 v[12:13], v[12:13], v[20:21]
    v_pk_add_f32 v[14:15], v[14:15], v[22:23]
    v_pk_add_f32 v[16:17], v[16:17], v[24:25]
    v_pk_add_f32 v[18:19], v[18:19], v[26:27]
    s_add_u32 m0, s48, 31744
    v_xor_b32 v3, 0x1f380, v2
    buffer_load_dwordx4 v3, s[8:11], s47 offen nt lds
    v_pk_add_f32 v[12:13], v[12:13], v[16:17]
    v_pk_add_f32 v[14:15], v[14:15], v[18:19]
    v_pk_add_f32 v[12:13], v[12:13], v[14:15]
    v_add_f32 v11, v12, v13
    v_mov_b32 v12, v11
    s_nop 1
    v_permlane16_swap_b32 v11, v12
    v_add_f32 v11, v11, v12
    v_mov_b32 v12, v11
    s_nop 1
    v_permlane32_swap_b32 v11, v12
    v_add_f32 v11, v11, v12
    v_mfma_f32_4x4x4_16b_bf16 v[12:15], v[44:45], v[64:65], 0 cbsz:4 abid:0
    v_mfma_f32_4x4x4_16b_bf16 v[16:19], v[44:45], v[66:67], 0 cbsz:4 abid:0
    v_mfma_f32_4x4x4_16b_bf16 v[20:23], v[44:45], v[68:69], 0 cbsz:4 abid:0
    v_mfma_f32_4x4x4_16b_bf16 v[24:27], v[44:45], v[70:71], 0 cbsz:4 abid:0
    v_mfma_f32_4x4x4_16b_bf16 v[12:15], v[44:45], v[72:73], v[12:15] cbsz:4 abid:4
    v_mfma_f32_4x4x4_16b_bf16 v[16:19], v[44:45], v[74:75], v[16:19] cbsz:4 abid:4
    v_mfma_f32_4x4x4_16b_bf16 v[20:23], v[44:45], v[76:77], v[20:23] cbsz:4 abid:4
    v_mfma_f32_4x4x4_16b_bf16 v[24:27], v[44:45], v[78:79], v[24:27] cbsz:4 abid:4
    v_mfma_f32_4x4x4_16b_bf16 v[12:15], v[44:45], v[80:81], v[12:15] cbsz:4 abid:8
    v_mfma_f32_4x4x4_16b_bf16 v[16:19], v[44:45], v[82:83], v[16:19] cbsz:4 abid:8
    v_mfma_f32_4x4x4_16b_bf16 v[20:23], v[44:45], v[84:85], v[20:23] cbsz:4 abid:8
    v_mfma_f32_4x4x4_16b_bf16 v[24:27], v[44:45], v[86:87], v[24:27] cbsz:4 abid:8
    v_mfma_f32_4x4x4_16b_bf16 v[12:15], v[44:45], v[88:89], v[12:15] cbsz:4 abid:12
    s_add_u32 m0, s48, 0
    v_xor_b32 v3, 0x20000, v2
    buffer_load_dwordx4 v3, s[8:11], s47 offen nt lds
    v_mfma_f32_4x4x4_16b_bf16 v[16:19], v[44:45], v[90:91], v[16:19] cbsz:4 abid:12
    v_mfma_f32_4x4x4_16b_bf16 v[20:23], v[44:45], v[92:93], v[20:23] cbsz:4 abid:12
    v_mfma_f32_4x4x4_16b_bf16 v[24:27], v[44:45], v[94:95], v[24:27] cbsz:4 abid:12
    v_mfma_f32_4x4x4_16b_bf16 v[12:15], v[46:47], v[96:97], v[12:15] cbsz:4 abid:0
    v_mfma_f32_4x4x4_16b_bf16 v[16:19], v[46:47], v[98:99], v[16:19] cbsz:4 abid:0
    v_mfma_f32_4x4x4_16b_bf16 v[20:23], v[46:47], v[100:101], v[20:23] cbsz:4 abid:0
    v_mfma_f32_4x4x4_16b_bf16 v[24:27], v[46:47], v[102:103], v[24:27] cbsz:4 abid:0
    v_mfma_f32_4x4x4_16b_bf16 v[12:15], v[46:47], v[104:105], v[12:15] cbsz:4 abid:4
    v_mfma_f32_4x4x4_16b_bf16 v[16:19], v[46:47], v[106:107], v[16:19] cbsz:4 abid:4
    v_mfma_f32_4x4x4_16b_bf16 v[20:23], v[46:47], v[108:109], v[20:23] cbsz:4 abid:4
    v_mfma_f32_4x4x4_16b_bf16 v[24:27], v[46:47], v[110:111], v[24:27] cbsz:4 abid:4
    v_mfma_f32_4x4x4_16b_bf16 v[12:15], v[46:47], v[112:113], v[12:15] cbsz:4 abid:8
    v_mfma_f32_4x4x4_16b_bf16 v[16:19], v[46:47], v[114:115], v[16:19] cbsz:4 abid:8
    v_mfma_f32_4x4x4_16b_bf16 v[20:23], v[46:47], v[116:117], v[20:23] cbsz:4 abid:8
    v_mfma_f32_4x4x4_16b_bf16 v[24:27], v[46:47], v[118:119], v[24:27] cbsz:4 abid:8
    v_mfma_f32_4x4x4_16b_bf16 v[12:15], v[46:47], v[120:121], v[12:15] cbsz:4 abid:12
    v_mfma_f32_4x4x4_16b_bf16 v[16:19], v[46:47], v[122:123], v[16:19] cbsz:4 abid:12
    v_mfma_f32_4x4x4_16b_bf16 v[20:23], v[46:47], v[124:125], v[20:23] cbsz:4 abid:12
    v_mfma_f32_4x4x4_16b_bf16 v[24:27], v[46:47], v[126:127], v[24:27] cbsz:4 abid:12
    s_add_u32 m0, s48, 1024
    v_xor_b32 v3, 0x21080, v2
    buffer_load_dwordx4 v3, s[8:11], s47 offen nt lds
    s_add_u32 m0, s48, 2048
    v_xor_b32 v3, 0x22100, v2
    buffer_load_dwordx4 v3, s[8:11], s47 offen nt lds
    s_add_u32 m0, s48, 3072
    v_xor_b32 v3, 0x23180, v2
    buffer_load_dwordx4 v3, s[8:11], s47 offen nt lds
    s_waitcnt vmcnt(12)
    v_xor_b32 v6, 128, v5
    v_xor_b32 v7, 0x240, v5
    v_xor_b32 v8, 0x2c0, v5
    ds_read_b64_tr_b16 v[128:129], v5 offset:16384
    ds_read_b64_tr_b16 v[130:131], v6 offset:16384
    ds_read_b64_tr_b16 v[132:133], v5 offset:16640
    ds_read_b64_tr_b16 v[134:135], v6 offset:16640
    ds_read_b64_tr_b16 v[136:137], v5 offset:18688
    ds_read_b64_tr_b16 v[138:139], v6 offset:18688
    ds_read_b64_tr_b16 v[140:141], v5 offset:18432
    ds_read_b64_tr_b16 v[142:143], v6 offset:18432
    ds_read_b64_tr_b16 v[144:145], v7 offset:20480
    ds_read_b64_tr_b16 v[146:147], v8 offset:20480
    ds_read_b64_tr_b16 v[148:149], v7 offset:20736
    ds_read_b64_tr_b16 v[150:151], v8 offset:20736
    ds_read_b64_tr_b16 v[152:153], v7 offset:22784
    ds_read_b64_tr_b16 v[154:155], v8 offset:22784
    ds_read_b64_tr_b16 v[156:157], v7 offset:22528
    ds_read_b64_tr_b16 v[158:159], v8 offset:22528
    s_waitcnt lgkmcnt(0)
    v_mfma_f32_4x4x4_16b_bf16 v[12:15], v[48:49], v[128:129], v[12:15] cbsz:4 abid:0
    v_mfma_f32_4x4x4_16b_bf16 v[16:19], v[48:49], v[130:131], v[16:19] cbsz:4 abid:0
    v_mfma_f32_4x4x4_16b_bf16 v[20:23], v[48:49], v[132:133], v[20:23] cbsz:4 abid:0
    v_mfma_f32_4x4x4_16b_bf16 v[24:27], v[48:49], v[134:135], v[24:27] cbsz:4 abid:0
    v_mfma_f32_4x4x4_16b_bf16 v[12:15], v[48:49], v[136:137], v[12:15] cbsz:4 abid:4
    v_mfma_f32_4x4x4_16b_bf16 v[16:19], v[48:49], v[138:139], v[16:19] cbsz:4 abid:4
    v_mfma_f32_4x4x4_16b_bf16 v[20:23], v[48:49], v[140:141], v[20:23] cbsz:4 abid:4
    v_mfma_f32_4x4x4_16b_bf16 v[24:27], v[48:49], v[142:143], v[24:27] cbsz:4 abid:4
    v_mfma_f32_4x4x4_16b_bf16 v[12:15], v[48:49], v[144:145], v[12:15] cbsz:4 abid:8
    s_add_u32 m0, s48, 4096
    v_xor_b32 v3, 0x24200, v2
    buffer_load_dwordx4 v3, s[8:11], s47 offen nt lds
    v_mfma_f32_4x4x4_16b_bf16 v[16:19], v[48:49], v[146:147], v[16:19] cbsz:4 abid:8
    v_mfma_f32_4x4x4_16b_bf16 v[20:23], v[48:49], v[148:149], v[20:23] cbsz:4 abid:8
    v_mfma_f32_4x4x4_16b_bf16 v[24:27], v[48:49], v[150:151], v[24:27] cbsz:4 abid:8
    v_mfma_f32_4x4x4_16b_bf16 v[12:15], v[48:49], v[152:153], v[12:15] cbsz:4 abid:12
    v_mfma_f32_4x4x4_16b_bf16 v[16:19], v[48:49], v[154:155], v[16:19] cbsz:4 abid:12
    v_mfma_f32_4x4x4_16b_bf16 v[20:23], v[48:49], v[156:157], v[20:23] cbsz:4 abid:12
    v_mfma_f32_4x4x4_16b_bf16 v[24:27], v[48:49], v[158:159], v[24:27] cbsz:4 abid:12
    s_add_u32 m0, s48, 5120
    v_xor_b32 v3, 0x25280, v2
    buffer_load_dwordx4 v3, s[8:11], s47 offen nt lds
    s_add_u32 m0, s48, 6144
    v_xor_b32 v3, 0x26300, v2
    buffer_load_dwordx4 v3, s[8:11], s47 offen nt lds
    s_add_u32 m0, s48, 7168
    v_xor_b32 v3, 0x27380, v2
    buffer_load_dwordx4 v3, s[8:11], s47 offen nt lds
    s_add_u32 m0, s48, 8192
    v_xor_b32 v3, 0x28000, v2
    buffer_load_dwordx4 v3, s[8:11], s47 offen nt lds
    s_add_u32 m0, s48, 9216
    v_xor_b32 v3, 0x29080, v2
    buffer_load_dwordx4 v3, s[8:11], s47 offen nt lds
    s_add_u32 m0, s48, 10240
    v_xor_b32 v3, 0x2a100, v2
    buffer_load_dwordx4 v3, s[8:11], s47 offen nt lds
    s_add_u32 m0, s48, 11264
    v_xor_b32 v3, 0x2b180, v2
    buffer_load_dwordx4 v3, s[8:11], s47 offen nt lds
    s_waitcnt vmcnt(12)
    v_xor_b32 v6, 128, v5
    v_xor_b32 v7, 0x240, v5
    v_xor_b32 v8, 0x2c0, v5
    ds_read_b64_tr_b16 v[160:161], v5 offset:24576
    ds_read_b64_tr_b16 v[162:163], v6 offset:24576
    ds_read_b64_tr_b16 v[164:165], v5 offset:24832
    ds_read_b64_tr_b16 v[166:167], v6 offset:24832
    ds_read_b64_tr_b16 v[168:169], v5 offset:26880
    ds_read_b64_tr_b16 v[170:171], v6 offset:26880
    ds_read_b64_tr_b16 v[172:173], v5 offset:26624
    ds_read_b64_tr_b16 v[174:175], v6 offset:26624
    ds_read_b64_tr_b16 v[176:177], v7 offset:28672
    ds_read_b64_tr_b16 v[178:179], v8 offset:28672
    ds_read_b64_tr_b16 v[180:181], v7 offset:28928
    ds_read_b64_tr_b16 v[182:183], v8 offset:28928
    ds_read_b64_tr_b16 v[184:185], v7 offset:30976
    ds_read_b64_tr_b16 v[186:187], v8 offset:30976
    ds_read_b64_tr_b16 v[188:189], v7 offset:30720
    ds_read_b64_tr_b16 v[190:191], v8 offset:30720
    s_waitcnt lgkmcnt(0)
    v_mfma_f32_4x4x4_16b_bf16 v[12:15], v[50:51], v[160:161], v[12:15] cbsz:4 abid:0
    v_mfma_f32_4x4x4_16b_bf16 v[16:19], v[50:51], v[162:163], v[16:19] cbsz:4 abid:0
    v_mfma_f32_4x4x4_16b_bf16 v[20:23], v[50:51], v[164:165], v[20:23] cbsz:4 abid:0
    v_mfma_f32_4x4x4_16b_bf16 v[24:27], v[50:51], v[166:167], v[24:27] cbsz:4 abid:0
    v_mfma_f32_4x4x4_16b_bf16 v[12:15], v[50:51], v[168:169], v[12:15] cbsz:4 abid:4
    v_mfma_f32_4x4x4_16b_bf16 v[16:19], v[50:51], v[170:171], v[16:19] cbsz:4 abid:4
    v_mfma_f32_4x4x4_16b_bf16 v[20:23], v[50:51], v[172:173], v[20:23] cbsz:4 abid:4
    v_mfma_f32_4x4x4_16b_bf16 v[24:27], v[50:51], v[174:175], v[24:27] cbsz:4 abid:4
    v_mfma_f32_4x4x4_16b_bf16 v[12:15], v[50:51], v[176:177], v[12:15] cbsz:4 abid:8
    s_add_u32 m0, s48, 12288
    v_xor_b32 v3, 0x2c200, v2
    buffer_load_dwordx4 v3, s[8:11], s47 offen nt lds
    v_mfma_f32_4x4x4_16b_bf16 v[16:19], v[50:51], v[178:179], v[16:19] cbsz:4 abid:8
    v_mfma_f32_4x4x4_16b_bf16 v[20:23], v[50:51], v[180:181], v[20:23] cbsz:4 abid:8
    v_mfma_f32_4x4x4_16b_bf16 v[24:27], v[50:51], v[182:183], v[24:27] cbsz:4 abid:8
    v_mfma_f32_4x4x4_16b_bf16 v[12:15], v[50:51], v[184:185], v[12:15] cbsz:4 abid:12
    v_mfma_f32_4x4x4_16b_bf16 v[16:19], v[50:51], v[186:187], v[16:19] cbsz:4 abid:12
    v_mfma_f32_4x4x4_16b_bf16 v[20:23], v[50:51], v[188:189], v[20:23] cbsz:4 abid:12
    v_mfma_f32_4x4x4_16b_bf16 v[24:27], v[50:51], v[190:191], v[24:27] cbsz:4 abid:12
    s_add_u32 m0, s48, 13312
    v_xor_b32 v3, 0x2d280, v2
    buffer_load_dwordx4 v3, s[8:11], s47 offen nt lds
    s_add_u32 m0, s48, 14336
    v_xor_b32 v3, 0x2e300, v2
    buffer_load_dwordx4 v3, s[8:11], s47 offen nt lds
    s_add_u32 m0, s48, 15360
    v_xor_b32 v3, 0x2f380, v2
    buffer_load_dwordx4 v3, s[8:11], s47 offen nt lds
    s_add_u32 m0, s48, 16384
    v_xor_b32 v3, 0x30000, v2
    buffer_load_dwordx4 v3, s[8:11], s47 offen nt lds
    s_add_u32 m0, s48, 17408
    v_xor_b32 v3, 0x31080, v2
    buffer_load_dwordx4 v3, s[8:11], s47 offen nt lds
    s_add_u32 m0, s48, 18432
    v_xor_b32 v3, 0x32100, v2
    buffer_load_dwordx4 v3, s[8:11], s47 offen nt lds
    s_add_u32 m0, s48, 19456
    v_xor_b32 v3, 0x33180, v2
    buffer_load_dwordx4 v3, s[8:11], s47 offen nt lds
    s_waitcnt vmcnt(12)
    v_xor_b32 v6, 128, v5
    v_xor_b32 v7, 0x240, v5
    v_xor_b32 v8, 0x2c0, v5
    ds_read_b64_tr_b16 v[192:193], v5 offset:0
    ds_read_b64_tr_b16 v[194:195], v6 offset:0
    ds_read_b64_tr_b16 v[196:197], v5 offset:256
    ds_read_b64_tr_b16 v[198:199], v6 offset:256
    ds_read_b64_tr_b16 v[200:201], v5 offset:2304
    ds_read_b64_tr_b16 v[202:203], v6 offset:2304
    ds_read_b64_tr_b16 v[204:205], v5 offset:2048
    ds_read_b64_tr_b16 v[206:207], v6 offset:2048
    ds_read_b64_tr_b16 v[208:209], v7 offset:4096
    ds_read_b64_tr_b16 v[210:211], v8 offset:4096
    ds_read_b64_tr_b16 v[212:213], v7 offset:4352
    ds_read_b64_tr_b16 v[214:215], v8 offset:4352
    ds_read_b64_tr_b16 v[216:217], v7 offset:6400
    ds_read_b64_tr_b16 v[218:219], v8 offset:6400
    ds_read_b64_tr_b16 v[220:221], v7 offset:6144
    ds_read_b64_tr_b16 v[222:223], v8 offset:6144
    s_waitcnt lgkmcnt(0)
    v_mfma_f32_4x4x4_16b_bf16 v[12:15], v[52:53], v[192:193], v[12:15] cbsz:4 abid:0
    v_mfma_f32_4x4x4_16b_bf16 v[16:19], v[52:53], v[194:195], v[16:19] cbsz:4 abid:0
    v_mfma_f32_4x4x4_16b_bf16 v[20:23], v[52:53], v[196:197], v[20:23] cbsz:4 abid:0
    v_mfma_f32_4x4x4_16b_bf16 v[24:27], v[52:53], v[198:199], v[24:27] cbsz:4 abid:0
    v_mfma_f32_4x4x4_16b_bf16 v[12:15], v[52:53], v[200:201], v[12:15] cbsz:4 abid:4
    v_mfma_f32_4x4x4_16b_bf16 v[16:19], v[52:53], v[202:203], v[16:19] cbsz:4 abid:4
    v_mfma_f32_4x4x4_16b_bf16 v[20:23], v[52:53], v[204:205], v[20:23] cbsz:4 abid:4
    v_mfma_f32_4x4x4_16b_bf16 v[24:27], v[52:53], v[206:207], v[24:27] cbsz:4 abid:4
    v_mfma_f32_4x4x4_16b_bf16 v[12:15], v[52:53], v[208:209], v[12:15] cbsz:4 abid:8
    s_add_u32 m0, s48, 20480
    v_xor_b32 v3, 0x34200, v2
    buffer_load_dwordx4 v3, s[8:11], s47 offen nt lds
    v_mfma_f32_4x4x4_16b_bf16 v[16:19], v[52:53], v[210:211], v[16:19] cbsz:4 abid:8
    v_mfma_f32_4x4x4_16b_bf16 v[20:23], v[52:53], v[212:213], v[20:23] cbsz:4 abid:8
    v_mfma_f32_4x4x4_16b_bf16 v[24:27], v[52:53], v[214:215], v[24:27] cbsz:4 abid:8
    v_mfma_f32_4x4x4_16b_bf16 v[12:15], v[52:53], v[216:217], v[12:15] cbsz:4 abid:12
    v_mfma_f32_4x4x4_16b_bf16 v[16:19], v[52:53], v[218:219], v[16:19] cbsz:4 abid:12
    v_mfma_f32_4x4x4_16b_bf16 v[20:23], v[52:53], v[220:221], v[20:23] cbsz:4 abid:12
    v_mfma_f32_4x4x4_16b_bf16 v[24:27], v[52:53], v[222:223], v[24:27] cbsz:4 abid:12
    s_add_u32 m0, s48, 21504
    v_xor_b32 v3, 0x35280, v2
    buffer_load_dwordx4 v3, s[8:11], s47 offen nt lds
    s_add_u32 m0, s48, 22528
    v_xor_b32 v3, 0x36300, v2
    buffer_load_dwordx4 v3, s[8:11], s47 offen nt lds
    s_add_u32 m0, s48, 23552
    v_xor_b32 v3, 0x37380, v2
    buffer_load_dwordx4 v3, s[8:11], s47 offen nt lds
    s_add_u32 m0, s48, 24576
    v_xor_b32 v3, 0x38000, v2
    buffer_load_dwordx4 v3, s[8:11], s47 offen nt lds
    s_add_u32 m0, s48, 25600
    v_xor_b32 v3, 0x39080, v2
    buffer_load_dwordx4 v3, s[8:11], s47 offen nt lds
    s_add_u32 m0, s48, 26624
    v_xor_b32 v3, 0x3a100, v2
    buffer_load_dwordx4 v3, s[8:11], s47 offen nt lds
    s_add_u32 m0, s48, 27648
    v_xor_b32 v3, 0x3b180, v2
    buffer_load_dwordx4 v3, s[8:11], s47 offen nt lds
    s_waitcnt vmcnt(12)
    v_xor_b32 v6, 128, v5
    v_xor_b32 v7, 0x240, v5
    v_xor_b32 v8, 0x2c0, v5
    ds_read_b64_tr_b16 v[224:225], v5 offset:8192
    ds_read_b64_tr_b16 v[226:227], v6 offset:8192
    ds_read_b64_tr_b16 v[228:229], v5 offset:8448
    ds_read_b64_tr_b16 v[230:231], v6 offset:8448
    ds_read_b64_tr_b16 v[232:233], v5 offset:10496
    ds_read_b64_tr_b16 v[234:235], v6 offset:10496
    ds_read_b64_tr_b16 v[236:237], v5 offset:10240
    ds_read_b64_tr_b16 v[238:239], v6 offset:10240
    ds_read_b64_tr_b16 v[240:241], v7 offset:12288
    ds_read_b64_tr_b16 v[242:243], v8 offset:12288
    ds_read_b64_tr_b16 v[244:245], v7 offset:12544
    ds_read_b64_tr_b16 v[246:247], v8 offset:12544
    ds_read_b64_tr_b16 v[248:249], v7 offset:14592
    ds_read_b64_tr_b16 v[250:251], v8 offset:14592
    ds_read_b64_tr_b16 v[252:253], v7 offset:14336
    ds_read_b64_tr_b16 v[254:255], v8 offset:14336
    s_waitcnt lgkmcnt(0)
    v_mfma_f32_4x4x4_16b_bf16 v[12:15], v[54:55], v[224:225], v[12:15] cbsz:4 abid:0
    v_mfma_f32_4x4x4_16b_bf16 v[16:19], v[54:55], v[226:227], v[16:19] cbsz:4 abid:0
    v_mfma_f32_4x4x4_16b_bf16 v[20:23], v[54:55], v[228:229], v[20:23] cbsz:4 abid:0
    v_mfma_f32_4x4x4_16b_bf16 v[24:27], v[54:55], v[230:231], v[24:27] cbsz:4 abid:0
    v_mfma_f32_4x4x4_16b_bf16 v[12:15], v[54:55], v[232:233], v[12:15] cbsz:4 abid:4
    v_mfma_f32_4x4x4_16b_bf16 v[16:19], v[54:55], v[234:235], v[16:19] cbsz:4 abid:4
    v_mfma_f32_4x4x4_16b_bf16 v[20:23], v[54:55], v[236:237], v[20:23] cbsz:4 abid:4
    v_mfma_f32_4x4x4_16b_bf16 v[24:27], v[54:55], v[238:239], v[24:27] cbsz:4 abid:4
    v_mfma_f32_4x4x4_16b_bf16 v[12:15], v[54:55], v[240:241], v[12:15] cbsz:4 abid:8
    s_add_u32 m0, s48, 28672
    v_xor_b32 v3, 0x3c200, v2
    buffer_load_dwordx4 v3, s[8:11], s47 offen nt lds
    v_mfma_f32_4x4x4_16b_bf16 v[16:19], v[54:55], v[242:243], v[16:19] cbsz:4 abid:8
    v_mfma_f32_4x4x4_16b_bf16 v[20:23], v[54:55], v[244:245], v[20:23] cbsz:4 abid:8
    v_mfma_f32_4x4x4_16b_bf16 v[24:27], v[54:55], v[246:247], v[24:27] cbsz:4 abid:8
    v_mfma_f32_4x4x4_16b_bf16 v[12:15], v[54:55], v[248:249], v[12:15] cbsz:4 abid:12
    v_mfma_f32_4x4x4_16b_bf16 v[16:19], v[54:55], v[250:251], v[16:19] cbsz:4 abid:12
    v_mfma_f32_4x4x4_16b_bf16 v[20:23], v[54:55], v[252:253], v[20:23] cbsz:4 abid:12
    v_mfma_f32_4x4x4_16b_bf16 v[24:27], v[54:55], v[254:255], v[24:27] cbsz:4 abid:12
    s_add_u32 m0, s48, 29696
    v_xor_b32 v3, 0x3d280, v2
    buffer_load_dwordx4 v3, s[8:11], s47 offen nt lds
    s_add_u32 m0, s48, 30720
    v_xor_b32 v3, 0x3e300, v2
    buffer_load_dwordx4 v3, s[8:11], s47 offen nt lds
    s_add_u32 m0, s48, 31744
    v_xor_b32 v3, 0x3f380, v2
    buffer_load_dwordx4 v3, s[8:11], s47 offen nt lds
    s_waitcnt vmcnt(8)
    v_xor_b32 v6, 128, v5
    v_xor_b32 v7, 0x240, v5
    v_xor_b32 v8, 0x2c0, v5
    ds_read_b64_tr_b16 v[28:29], v5 offset:16384
    ds_read_b64_tr_b16 v[30:31], v6 offset:16384
    ds_read_b64_tr_b16 v[32:33], v5 offset:16640
    ds_read_b64_tr_b16 v[34:35], v6 offset:16640
    ds_read_b64_tr_b16 v[36:37], v5 offset:18688
    ds_read_b64_tr_b16 v[38:39], v6 offset:18688
    ds_read_b64_tr_b16 v[40:41], v5 offset:18432
    ds_read_b64_tr_b16 v[42:43], v6 offset:18432
    s_waitcnt lgkmcnt(7)
    v_mfma_f32_4x4x4_16b_bf16 v[12:15], v[56:57], v[28:29], v[12:15] cbsz:4 abid:0
    ds_read_b64_tr_b16 v[28:29], v7 offset:20480
    s_waitcnt lgkmcnt(7)
    v_mfma_f32_4x4x4_16b_bf16 v[16:19], v[56:57], v[30:31], v[16:19] cbsz:4 abid:0
    ds_read_b64_tr_b16 v[30:31], v8 offset:20480
    s_waitcnt lgkmcnt(7)
    v_mfma_f32_4x4x4_16b_bf16 v[20:23], v[56:57], v[32:33], v[20:23] cbsz:4 abid:0
    ds_read_b64_tr_b16 v[32:33], v7 offset:20736
    s_waitcnt lgkmcnt(7)
    v_mfma_f32_4x4x4_16b_bf16 v[24:27], v[56:57], v[34:35], v[24:27] cbsz:4 abid:0
    ds_read_b64_tr_b16 v[34:35], v8 offset:20736
    s_waitcnt lgkmcnt(7)
    v_mfma_f32_4x4x4_16b_bf16 v[12:15], v[56:57], v[36:37], v[12:15] cbsz:4 abid:4
    ds_read_b64_tr_b16 v[36:37], v7 offset:22784
    s_waitcnt lgkmcnt(7)
    v_mfma_f32_4x4x4_16b_bf16 v[16:19], v[56:57], v[38:39], v[16:19] cbsz:4 abid:4
    ds_read_b64_tr_b16 v[38:39], v8 offset:22784
    s_waitcnt lgkmcnt(7)
    v_mfma_f32_4x4x4_16b_bf16 v[20:23], v[56:57], v[40:41], v[20:23] cbsz:4 abid:4
    ds_read_b64_tr_b16 v[40:41], v7 offset:22528
    s_waitcnt lgkmcnt(7)
    v_mfma_f32_4x4x4_16b_bf16 v[24:27], v[56:57], v[42:43], v[24:27] cbsz:4 abid:4
    ds_read_b64_tr_b16 v[42:43], v8 offset:22528
    s_waitcnt lgkmcnt(7)
    v_mfma_f32_4x4x4_16b_bf16 v[12:15], v[56:57], v[28:29], v[12:15] cbsz:4 abid:8
    s_waitcnt lgkmcnt(6)
    v_mfma_f32_4x4x4_16b_bf16 v[16:19], v[56:57], v[30:31], v[16:19] cbsz:4 abid:8
    s_waitcnt lgkmcnt(5)
    v_mfma_f32_4x4x4_16b_bf16 v[20:23], v[56:57], v[32:33], v[20:23] cbsz:4 abid:8
    s_waitcnt lgkmcnt(4)
    v_mfma_f32_4x4x4_16b_bf16 v[24:27], v[56:57], v[34:35], v[24:27] cbsz:4 abid:8
    s_waitcnt lgkmcnt(3)
    v_mfma_f32_4x4x4_16b_bf16 v[12:15], v[56:57], v[36:37], v[12:15] cbsz:4 abid:12
    s_waitcnt lgkmcnt(2)
    v_mfma_f32_4x4x4_16b_bf16 v[16:19], v[56:57], v[38:39], v[16:19] cbsz:4 abid:12
    s_waitcnt lgkmcnt(1)
    v_mfma_f32_4x4x4_16b_bf16 v[20:23], v[56:57], v[40:41], v[20:23] cbsz:4 abid:12
    s_waitcnt lgkmcnt(0)
    v_mfma_f32_4x4x4_16b_bf16 v[24:27], v[56:57], v[42:43], v[24:27] cbsz:4 abid:12
    v_lshrrev_b32 v6, 2, v0
    v_mul_u32_u24 v6, 896, v6
    v_and_b32 v7, 3, v0
    v_lshl_add_u32 v6, v7, 4, v6
    s_add_u32 m0, s48, 0
    s_nop 0
    buffer_load_dwordx4 v6, s[92:95], s61 offen  lds
    s_add_u32 m0, s48, 1024
    v_add_u32 v6, 14336, v6
    buffer_load_dwordx4 v6, s[92:95], s61 offen  lds
    s_add_u32 m0, s48, 2048
    v_add_u32 v6, 14336, v6
    buffer_load_dwordx4 v6, s[92:95], s61 offen  lds
    s_add_u32 m0, s48, 3072
    v_add_u32 v6, 14336, v6
    buffer_load_dwordx4 v6, s[92:95], s61 offen  lds
    s_add_u32 m0, s48, 4096
    v_add_u32 v6, 14336, v6
    buffer_load_dwordx4 v6, s[92:95], s61 offen  lds
    s_add_u32 m0, s48, 5120
    v_add_u32 v6, 14336, v6
    buffer_load_dwordx4 v6, s[92:95], s61 offen  lds
    s_add_u32 m0, s48, 6144
    v_add_u32 v6, 14336, v6
    buffer_load_dwordx4 v6, s[92:95], s61 offen  lds
    s_add_u32 m0, s48, 7168
    v_add_u32 v6, 14336, v6
    buffer_load_dwordx4 v6, s[92:95], s61 offen  lds
    v_lshrrev_b32 v6, 2, v0
    v_lshlrev_b32 v6, 13, v6
    v_and_b32 v7, 3, v0
    v_lshl_add_u32 v6, v7, 4, v6
    v_add_u32 v6, s49, v6
    s_add_u32 m0, s48, 8192
    s_nop 0
    global_load_lds_dwordx4 v6, s[22:23]
    s_add_u32 m0, s48, 9216
    v_add_u32 v6, 131072, v6
    global_load_lds_dwordx4 v6, s[22:23]
    s_add_u32 m0, s48, 10240
    v_add_u32 v6, 131072, v6
    global_load_lds_dwordx4 v6, s[22:23]
    s_add_u32 m0, s48, 11264
    v_add_u32 v6, 131072, v6
    global_load_lds_dwordx4 v6, s[22:23]
    s_add_u32 m0, s48, 12288
    v_add_u32 v6, 131072, v6
    global_load_lds_dwordx4 v6, s[22:23]
    s_add_u32 m0, s48, 13312
    v_add_u32 v6, 131072, v6
    global_load_lds_dwordx4 v6, s[22:23]
    s_add_u32 m0, s48, 14336
    v_add_u32 v6, 131072, v6
    global_load_lds_dwordx4 v6, s[22:23]
    s_waitcnt vmcnt(15)
    v_xor_b32 v6, 128, v5
    v_xor_b32 v7, 0x240, v5
    v_xor_b32 v8, 0x2c0, v5
    ds_read_b64_tr_b16 v[28:29], v5 offset:24576
    ds_read_b64_tr_b16 v[30:31], v6 offset:24576
    ds_read_b64_tr_b16 v[32:33], v5 offset:24832
    ds_read_b64_tr_b16 v[34:35], v6 offset:24832
    ds_read_b64_tr_b16 v[36:37], v5 offset:26880
    ds_read_b64_tr_b16 v[38:39], v6 offset:26880
    ds_read_b64_tr_b16 v[40:41], v5 offset:26624
    ds_read_b64_tr_b16 v[42:43], v6 offset:26624
    s_waitcnt lgkmcnt(7)
    v_mfma_f32_4x4x4_16b_bf16 v[12:15], v[58:59], v[28:29], v[12:15] cbsz:4 abid:0
    ds_read_b64_tr_b16 v[28:29], v7 offset:28672
    s_waitcnt lgkmcnt(7)
    v_mfma_f32_4x4x4_16b_bf16 v[16:19], v[58:59], v[30:31], v[16:19] cbsz:4 abid:0
    ds_read_b64_tr_b16 v[30:31], v8 offset:28672
    s_waitcnt lgkmcnt(7)
    v_mfma_f32_4x4x4_16b_bf16 v[20:23], v[58:59], v[32:33], v[20:23] cbsz:4 abid:0
    ds_read_b64_tr_b16 v[32:33], v7 offset:28928
    s_waitcnt lgkmcnt(7)
    v_mfma_f32_4x4x4_16b_bf16 v[24:27], v[58:59], v[34:35], v[24:27] cbsz:4 abid:0
    ds_read_b64_tr_b16 v[34:35], v8 offset:28928
    s_waitcnt lgkmcnt(7)
    v_mfma_f32_4x4x4_16b_bf16 v[12:15], v[58:59], v[36:37], v[12:15] cbsz:4 abid:4
    ds_read_b64_tr_b16 v[36:37], v7 offset:30976
    s_waitcnt lgkmcnt(7)
    v_mfma_f32_4x4x4_16b_bf16 v[16:19], v[58:59], v[38:39], v[16:19] cbsz:4 abid:4
    ds_read_b64_tr_b16 v[38:39], v8 offset:30976
    s_waitcnt lgkmcnt(7)
    v_mfma_f32_4x4x4_16b_bf16 v[20:23], v[58:59], v[40:41], v[20:23] cbsz:4 abid:4
    ds_read_b64_tr_b16 v[40:41], v7 offset:30720
    s_waitcnt lgkmcnt(7)
    v_mfma_f32_4x4x4_16b_bf16 v[24:27], v[58:59], v[42:43], v[24:27] cbsz:4 abid:4
    ds_read_b64_tr_b16 v[42:43], v8 offset:30720
    s_waitcnt lgkmcnt(7)
    v_mfma_f32_4x4x4_16b_bf16 v[12:15], v[58:59], v[28:29], v[12:15] cbsz:4 abid:8
    s_waitcnt lgkmcnt(6)
    v_mfma_f32_4x4x4_16b_bf16 v[16:19], v[58:59], v[30:31], v[16:19] cbsz:4 abid:8
    s_waitcnt lgkmcnt(5)
    v_mfma_f32_4x4x4_16b_bf16 v[20:23], v[58:59], v[32:33], v[20:23] cbsz:4 abid:8
    s_waitcnt lgkmcnt(4)
    v_mfma_f32_4x4x4_16b_bf16 v[24:27], v[58:59], v[34:35], v[24:27] cbsz:4 abid:8
    s_waitcnt lgkmcnt(3)
    v_mfma_f32_4x4x4_16b_bf16 v[12:15], v[58:59], v[36:37], v[12:15] cbsz:4 abid:12
    s_waitcnt lgkmcnt(2)
    v_mfma_f32_4x4x4_16b_bf16 v[16:19], v[58:59], v[38:39], v[16:19] cbsz:4 abid:12
    s_waitcnt lgkmcnt(1)
    v_mfma_f32_4x4x4_16b_bf16 v[20:23], v[58:59], v[40:41], v[20:23] cbsz:4 abid:12
    s_waitcnt lgkmcnt(0)
    v_mfma_f32_4x4x4_16b_bf16 v[24:27], v[58:59], v[42:43], v[24:27] cbsz:4 abid:12
    s_barrier
    s_lshl_b32 s76, s42, 11
    v_lshl_add_u32 v28, v0, 2, s76
    v_add_u32 v28, 14336, v28
    ds_write2st64_b32 v28, v12, v13 offset0:0 offset1:4
    ds_write2st64_b32 v28, v16, v17 offset0:1 offset1:5
    ds_write2st64_b32 v28, v20, v21 offset0:2 offset1:6
    ds_write2st64_b32 v28, v24, v25 offset0:3 offset1:7
    s_lshl_b32 s77, s42, 4
    v_lshl_add_u32 v29, v0, 3, s77
    s_mov_b64 exec, 3
    ds_write_b64 v29, v[10:11] offset:10240
    s_mov_b64 exec, -1
    s_lshl_b32 s76, s42, 9
    v_lshl_add_u32 v28, v0, 3, s76
    s_lshr_b32 s77, s42, 1
    s_lshl_b32 s77, s77, 3
    v_mov_b32 v29, s77
    s_lshr_b32 s55, s54, 1
    s_add_u32 s55, s55, 1
    s_lshl_b32 s76, s45, 11
    s_add_u32 s76, s76, 0x0
    s_lshl_b32 s78, s51, 7
    s_lshl3_add_u32 s78, s44, s78
    s_lshr_b32 s77, s77, 1
    s_add_u32 s78, s78, s77
    s_add_u32 s78, s78, 0x110000
    s_waitcnt lgkmcnt(0)
    s_barrier
    ds_read_b64 v[12:13], v29 offset:10240
    ds_read_b64 v[14:15], v29 offset:10256
    ds_read_b64 v[16:17], v29 offset:10272
    ds_read_b64 v[18:19], v29 offset:10288
    ds_read_b64 v[20:21], v28 offset:14336
    ds_read_b64 v[22:23], v28 offset:16384
    ds_read_b64 v[24:25], v28 offset:18432
    ds_read_b64 v[26:27], v28 offset:20480
    s_waitcnt lgkmcnt(4)
    v_max3_f32 v10, v12, v14, v16
    v_max_f32 v10, v10, v18
    v_sub_f32 v12, v12, v10
    v_sub_f32 v14, v14, v10
    v_sub_f32 v16, v16, v10
    v_sub_f32 v18, v18, v10
    v_exp_f32 v12, v12
    v_exp_f32 v14, v14
    v_exp_f32 v16, v16
    v_exp_f32 v18, v18
    v_mul_f32 v11, v12, v13
    v_fmac_f32 v11, v14, v15
    v_fmac_f32 v11, v16, v17
    v_fmac_f32 v11, v18, v19
    s_waitcnt lgkmcnt(0)
    v_pk_mul_f32 v[20:21], v[20:21], v[12:13] op_sel_hi:[1,0]
    v_rcp_f32 v32, v11
    v_log_f32 v11, v11
    v_pk_fma_f32 v[20:21], v[22:23], v[14:15], v[20:21] op_sel_hi:[1,0,1]
    v_pk_fma_f32 v[20:21], v[24:25], v[16:17], v[20:21] op_sel_hi:[1,0,1]
    v_pk_fma_f32 v[20:21], v[26:27], v[18:19], v[20:21] op_sel_hi:[1,0,1]
    v_add_f32 v10, v10, v11
    v_pk_mul_f32 v[20:21], v[20:21], v[32:33] op_sel_hi:[1,0]
    v_bfi_b32 v10, -16, v10, s55
    v_bfi_b32 v20, -16, v20, s55
    v_bfi_b32 v21, -16, v21, s55
    s_cmp_eq_u32 s50, 0
    s_cbranch_scc1 L_g_10
    buffer_store_dwordx2 v[20:21], v28, s[12:15], s76 offen
    s_mov_b64 exec, 1
    buffer_store_dword v10, off, s[12:15], s78
    s_branch L_e_11
L_g_10:
    buffer_store_dwordx2 v[20:21], v28, s[12:15], s76 offen sc1
    s_mov_b64 exec, 1
    buffer_store_dword v10, off, s[12:15], s78 sc1
L_e_11:
    s_mov_b64 exec, -1
    s_sub_u32 s59, s42, 1
    s_cmp_gt_u32 s59, 1
    s_cbranch_scc1 L_o_12
    s_lshr_b32 s80, s54, 1
    s_add_u32 s80, s80, 1
    s_sub_u32 s80, s80, s59
    s_cmp_eq_u32 s80, 0
    s_cbranch_scc1 L_o_12
    v_lshrrev_b32 v11, 3, v0
    v_mul_u32_u24 v11, 16384, v11
    v_and_b32 v10, 7, v0
    v_lshl_add_u32 v10, v10, 4, v11
    v_and_b32 v11, 56, v0
    s_lshl_b32 s76, s59, 19
    s_add_u32 s76, s76, s52
    s_add_u32 s77, s76, 0x20000
    s_lshl4_add_u32 s81, s59, s51
    s_lshl_b32 s78, s81, 7
    s_lshr_b32 s79, s44, 3
    s_lshl2_add_u32 s78, s79, s78
    s_add_u32 s78, s78, 0x110000
    s_branch L_pf_15
L_pr_14:
    s_mov_b64 exec, vcc
L_pf_15:
    buffer_load_dwordx4 v[12:15], v10, s[12:15], s76 offen sc1
    buffer_load_dwordx4 v[16:19], v10, s[12:15], s77 offen sc1
    buffer_load_dword v20, v11, s[12:15], s78 offen sc1
    buffer_load_dword v21, v11, s[12:15], s78 offen offset:64 sc1
    s_mov_b64 exec, -1
    s_sub_u32 s56, s56, 1
    s_cbranch_scc1 L_exit
    s_waitcnt vmcnt(0)
    v_xor_b32 v22, s80, v12
    v_bitop3_b32 v22, v22, v13, s80 bitop3:0xf6
    v_bitop3_b32 v22, v22, v14, s80 bitop3:0xf6
    v_bitop3_b32 v22, v22, v15, s80 bitop3:0xf6
    v_bitop3_b32 v22, v22, v16, s80 bitop3:0xf6
    v_bitop3_b32 v22, v22, v17, s80 bitop3:0xf6
    v_bitop3_b32 v22, v22, v18, s80 bitop3:0xf6
    v_bitop3_b32 v22, v22, v19, s80 bitop3:0xf6
    v_bitop3_b32 v22, v22, v20, s80 bitop3:0xf6
    v_bitop3_b32 v22, v22, v21, s80 bitop3:0xf6
    v_and_b32 v22, 15, v22
    v_cmp_ne_u32 vcc, 0, v22
    s_cbranch_vccnz L_pr_14
    v_max_f32 v22, v20, v21
    s_nop 1
    v_max_f32_dpp v22, v22, v22 row_ror:8 row_mask:0xf bank_mask:0xf
    v_mov_b32 v23, v22
    s_nop 1
    v_permlane16_swap_b32 v22, v23
    v_max_f32 v22, v22, v23
    v_mov_b32 v23, v22
    s_nop 1
    v_permlane32_swap_b32 v22, v23
    v_max_f32 v22, v22, v23
    v_sub_f32 v20, v20, v22
    v_sub_f32 v21, v21, v22
    v_exp_f32 v20, v20
    v_exp_f32 v21, v21
    s_nop 0
    v_pk_mul_f32 v[12:13], v[12:13], v[20:21] op_sel_hi:[1,0]
    v_pk_mul_f32 v[14:15], v[14:15], v[20:21] op_sel_hi:[1,0]
    v_pk_fma_f32 v[12:13], v[16:17], v[20:21], v[12:13] op_sel:[0,1,0] op_sel_hi:[1,1,1]
    v_pk_fma_f32 v[14:15], v[18:19], v[20:21], v[14:15] op_sel:[0,1,0] op_sel_hi:[1,1,1]
    v_add_f32 v16, v20, v21
    v_add_f32_dpp v12, v12, v12 row_ror:8 row_mask:0xf bank_mask:0xf
    v_add_f32_dpp v13, v13, v13 row_ror:8 row_mask:0xf bank_mask:0xf
    v_add_f32_dpp v14, v14, v14 row_ror:8 row_mask:0xf bank_mask:0xf
    v_add_f32_dpp v15, v15, v15 row_ror:8 row_mask:0xf bank_mask:0xf
    v_add_f32_dpp v16, v16, v16 row_ror:8 row_mask:0xf bank_mask:0xf
    v_mov_b32 v17, v12
    v_mov_b32 v18, v13
    v_mov_b32 v19, v14
    v_mov_b32 v20, v15
    v_mov_b32 v21, v16
    v_permlane16_swap_b32 v12, v17
    v_permlane16_swap_b32 v13, v18
    v_permlane16_swap_b32 v14, v19
    v_permlane16_swap_b32 v15, v20
    v_permlane16_swap_b32 v16, v21
    v_add_f32 v12, v12, v17
    v_add_f32 v13, v13, v18
    v_add_f32 v14, v14, v19
    v_add_f32 v15, v15, v20
    v_add_f32 v16, v16, v21
    v_mov_b32 v17, v12
    v_mov_b32 v18, v13
    v_mov_b32 v19, v14
    v_mov_b32 v20, v15
    v_mov_b32 v21, v16
    v_permlane32_swap_b32 v12, v17
    v_permlane32_swap_b32 v13, v18
    v_permlane32_swap_b32 v14, v19
    v_permlane32_swap_b32 v15, v20
    v_permlane32_swap_b32 v16, v21
    v_add_f32 v12, v12, v17
    v_add_f32 v13, v13, v18
    v_add_f32 v14, v14, v19
    v_add_f32 v15, v15, v20
    v_add_f32 v16, v16, v21
    v_rcp_f32 v16, v16
    s_lshl_b32 s76, s81, 11
    s_add_u32 s76, s76, 0x100000
    s_lshl_b32 s78, s44, 7
    s_add_u32 s78, s78, s76
    v_pk_mul_f32 v[12:13], v[12:13], v[16:17] op_sel_hi:[1,0]
    v_pk_mul_f32 v[14:15], v[14:15], v[16:17] op_sel_hi:[1,0]
    v_cvt_pk_bf16_f32 v13, v12, v13
    v_cvt_pk_bf16_f32 v15, v14, v15
    v_mov_b32 v16, 0xffff0000
    v_lshl_or_b32 v12, v13, 16, s80
    v_lshl_or_b32 v14, v15, 16, s80
    v_and_or_b32 v13, v13, v16, s80
    v_and_or_b32 v15, v15, v16, s80
    s_mov_b64 exec, 0xff
    s_cmp_eq_u32 s50, 0
    s_cbranch_scc1 L_g_16
    buffer_store_dwordx4 v[12:15], v10, s[12:15], s78 offen
    s_nop 0
    s_branch L_e_17
L_g_16:
    buffer_store_dwordx4 v[12:15], v10, s[12:15], s78 offen sc1
L_e_17:
    s_mov_b64 exec, -1
    v_lshrrev_b32 v6, 4, v0
    v_bfe_u32 v7, v0, 2, 2
    v_lshl_add_u32 v6, v6, 3, v7
    v_and_b32 v7, 3, v0
    v_lshlrev_b32 v7, 3, v7
    v_lshl_add_u32 v6, v6, 6, v7
    v_add_u32 v6, s48, v6
    ds_read_b64_tr_b16 v[32:33], v6 offset:0
    ds_read_b64_tr_b16 v[34:35], v6 offset:256
    ds_read_b64_tr_b16 v[36:37], v6 offset:2048
    ds_read_b64_tr_b16 v[38:39], v6 offset:2304
    ds_read_b64_tr_b16 v[40:41], v6 offset:4096
    ds_read_b64_tr_b16 v[42:43], v6 offset:4352
    ds_read_b64_tr_b16 v[44:45], v6 offset:6144
    ds_read_b64_tr_b16 v[46:47], v6 offset:6400
    ds_read_b64_tr_b16 v[48:49], v6 offset:32
    ds_read_b64_tr_b16 v[50:51], v6 offset:288
    ds_read_b64_tr_b16 v[52:53], v6 offset:2080
    ds_read_b64_tr_b16 v[54:55], v6 offset:2336
    ds_read_b64_tr_b16 v[56:57], v6 offset:4128
    ds_read_b64_tr_b16 v[58:59], v6 offset:4384
    ds_read_b64_tr_b16 v[60:61], v6 offset:6176
    ds_read_b64_tr_b16 v[62:63], v6 offset:6432
    s_lshl_b32 s78, s59, 10
    s_add_u32 s78, s78, 26624
    v_lshlrev_b32 v10, 4, v0
    s_nop 0
    s_branch L_pf_19
L_pr_18:
    s_mov_b64 exec, vcc
L_pf_19:
    buffer_load_dwordx4 v[16:19], v10, s[12:15], s76 offen sc1
    buffer_load_dwordx4 v[20:23], v10, s[12:15], s76 offen offset:1024 sc1
    s_mov_b64 exec, -1
    s_sub_u32 s56, s56, 1
    s_cbranch_scc1 L_exit
    s_waitcnt vmcnt(0)
    v_xor_b32 v11, s80, v16
    v_bitop3_b32 v11, v11, v17, s80 bitop3:0xf6
    v_bitop3_b32 v11, v11, v18, s80 bitop3:0xf6
    v_bitop3_b32 v11, v11, v19, s80 bitop3:0xf6
    v_bitop3_b32 v11, v11, v20, s80 bitop3:0xf6
    v_bitop3_b32 v11, v11, v21, s80 bitop3:0xf6
    v_bitop3_b32 v11, v11, v22, s80 bitop3:0xf6
    v_bitop3_b32 v11, v11, v23, s80 bitop3:0xf6
    v_and_b32 v11, 15, v11
    v_cmp_ne_u32 vcc, 0, v11
    s_cbranch_vccnz L_pr_18
    s_mov_b32 s77, 0x07060302
    v_perm_b32 v24, v17, v16, s77
    v_perm_b32 v25, v19, v18, s77
    v_perm_b32 v26, v21, v20, s77
    v_perm_b32 v27, v23, v22, s77
    v_lshlrev_b32 v10, 3, v0
    v_add_u32 v10, s78, v10
    ds_write_b64 v10, v[24:25]
    ds_write_b64 v10, v[26:27] offset:512
    s_branch L_j_13
L_o_12:
    s_waitcnt vmcnt(0)
    v_lshrrev_b32 v6, 4, v0
    v_bfe_u32 v7, v0, 2, 2
    v_lshl_add_u32 v6, v6, 3, v7
    v_and_b32 v7, 3, v0
    v_lshlrev_b32 v7, 3, v7
    v_lshl_add_u32 v6, v6, 6, v7
    v_add_u32 v6, s48, v6
    ds_read_b64_tr_b16 v[32:33], v6 offset:0
    ds_read_b64_tr_b16 v[34:35], v6 offset:256
    ds_read_b64_tr_b16 v[36:37], v6 offset:2048
    ds_read_b64_tr_b16 v[38:39], v6 offset:2304
    ds_read_b64_tr_b16 v[40:41], v6 offset:4096
    ds_read_b64_tr_b16 v[42:43], v6 offset:4352
    ds_read_b64_tr_b16 v[44:45], v6 offset:6144
    ds_read_b64_tr_b16 v[46:47], v6 offset:6400
    ds_read_b64_tr_b16 v[48:49], v6 offset:32
    ds_read_b64_tr_b16 v[50:51], v6 offset:288
    ds_read_b64_tr_b16 v[52:53], v6 offset:2080
    ds_read_b64_tr_b16 v[54:55], v6 offset:2336
    ds_read_b64_tr_b16 v[56:57], v6 offset:4128
    ds_read_b64_tr_b16 v[58:59], v6 offset:4384
    ds_read_b64_tr_b16 v[60:61], v6 offset:6176
    ds_read_b64_tr_b16 v[62:63], v6 offset:6432
L_j_13:
    v_and_b32 v10, 1, v0
    v_and_b32 v11, 48, v0
    v_lshl_add_u32 v10, v10, 10, v11
    s_lshl_b32 s76, s42, 8
    v_add_u32 v10, s76, v10
    v_lshl_add_u32 v11, v0, 2, s76
    v_add_u32 v11, 28672, v11
    s_waitcnt lgkmcnt(0)
    s_barrier
    ds_read_b128 v[12:15], v10 offset:26624
    ds_read_b128 v[16:19], v10 offset:26688
    ds_read_b128 v[20:23], v10 offset:26752
    ds_read_b128 v[24:27], v10 offset:26816
    s_waitcnt lgkmcnt(3)
    v_mfma_f32_16x16x32_bf16 v[6:9], v[12:15], v[32:35], 0
    v_mfma_f32_16x16x32_bf16 v[28:31], v[12:15], v[48:51], 0
    s_waitcnt lgkmcnt(2)
    v_mfma_f32_16x16x32_bf16 v[6:9], v[16:19], v[36:39], v[6:9]
    v_mfma_f32_16x16x32_bf16 v[28:31], v[16:19], v[52:55], v[28:31]
    s_waitcnt lgkmcnt(1)
    v_mfma_f32_16x16x32_bf16 v[6:9], v[20:23], v[40:43], v[6:9]
    v_mfma_f32_16x16x32_bf16 v[28:31], v[20:23], v[56:59], v[28:31]
    s_waitcnt lgkmcnt(0)
    v_mfma_f32_16x16x32_bf16 v[6:9], v[24:27], v[44:47], v[6:9]
    v_mfma_f32_16x16x32_bf16 v[28:31], v[24:27], v[60:63], v[28:31]
    s_mov_b64 exec, 0xffff
    s_nop 6
    ds_write2_b32 v11, v6, v28 offset0:0 offset1:16
    ds_write2_b32 v11, v7, v29 offset0:32 offset1:48
    s_mov_b64 exec, -1
    s_waitcnt lgkmcnt(0)
    s_barrier
    s_sub_u32 s59, s42, 1
    s_cmp_gt_u32 s59, 1
    s_cbranch_scc1 L_o_20
    s_lshr_b32 s80, s54, 1
    s_add_u32 s80, s80, 1
    s_sub_u32 s80, s80, s59
    s_cmp_eq_u32 s80, 0
    s_cbranch_scc1 L_o_20
    v_lshlrev_b32 v10, 2, v0
    s_lshl_b32 s76, s59, 7
    s_add_u32 s76, s76, 28672
    v_add_u32 v11, s76, v10
    ds_read2st64_b32 v[12:13], v11 offset0:0 offset1:1
    ds_read2st64_b32 v[14:15], v11 offset0:2 offset1:3
    s_mul_i32 s76, s59, 6
    s_add_u32 s76, s76, s54
    s_lshl_b32 s76, s76, 14
    s_add_u32 s76, s76, 0x260000
    s_add_u32 s76, s76, s53
    s_waitcnt lgkmcnt(0)
    v_pk_add_f32 v[12:13], v[12:13], v[14:15]
    v_add_f32 v12, v12, v13
    v_bfi_b32 v12, -16, v12, 1
    s_mov_b32 exec_hi, 0
    buffer_store_dword v12, v10, s[12:15], s76 offen sc1
    s_mov_b64 exec, -1
L_o_20:
    v_lshrrev_b32 v6, 4, v0
    v_bfe_u32 v7, v0, 2, 2
    v_lshl_add_u32 v6, v6, 3, v7
    v_and_b32 v7, 3, v0
    v_lshlrev_b32 v7, 3, v7
    v_lshl_add_u32 v6, v6, 6, v7
    v_add_u32 v6, s48, v6
    ds_read_b64_tr_b16 v[32:33], v6 offset:8192
    ds_read_b64_tr_b16 v[34:35], v6 offset:8448
    ds_read_b64_tr_b16 v[36:37], v6 offset:9984
    ds_read_b64_tr_b16 v[38:39], v6 offset:10240
    ds_read_b64_tr_b16 v[40:41], v6 offset:11776
    ds_read_b64_tr_b16 v[42:43], v6 offset:12032
    ds_read_b64_tr_b16 v[44:45], v6 offset:13568
    ds_read_b64_tr_b16 v[46:47], v6 offset:13824
    ds_read_b64_tr_b16 v[48:49], v6 offset:8224
    ds_read_b64_tr_b16 v[50:51], v6 offset:8480
    ds_read_b64_tr_b16 v[52:53], v6 offset:10016
    ds_read_b64_tr_b16 v[54:55], v6 offset:10272
    ds_read_b64_tr_b16 v[56:57], v6 offset:11808
    ds_read_b64_tr_b16 v[58:59], v6 offset:12064
    ds_read_b64_tr_b16 v[60:61], v6 offset:13600
    ds_read_b64_tr_b16 v[62:63], v6 offset:13856
    s_mov_b32 vcc_lo, -1
    s_mov_b32 vcc_hi, 0x0000ffff
    s_waitcnt lgkmcnt(0)
    v_cndmask_b32 v46, 0, v46, vcc
    v_cndmask_b32 v47, 0, v47, vcc
    v_cndmask_b32 v62, 0, v62, vcc
    v_cndmask_b32 v63, 0, v63, vcc
    s_cmp_gt_u32 s54, 1
    s_cbranch_scc1 L_n_21
    v_and_b32 v10, 7, v0
    v_lshlrev_b32 v10, 2, v10
L_tg_22:
    global_load_dword v11, v10, s[38:39] offset:128 sc1
    s_sub_u32 s56, s56, 1
    s_cbranch_scc1 L_exit
    s_waitcnt vmcnt(0)
    v_cmp_eq_u32 vcc, 0, v11
    s_nop 3
    s_cbranch_vccnz L_tg_22
    s_mul_i32 s76, s42, 5120
    s_add_u32 s76, s76, 0x2a0000
    s_add_u32 s77, s76, 4096
    v_lshlrev_b32 v10, 4, v0
    s_nop 0
    s_branch L_pf_24
L_pr_23:
    s_mov_b64 exec, vcc
L_pf_24:
    buffer_load_dwordx4 v[12:15], v10, s[12:15], s76 offen offset:0 sc1
    buffer_load_dwordx4 v[16:19], v10, s[12:15], s76 offen offset:1024 sc1
    buffer_load_dwordx4 v[20:23], v10, s[12:15], s76 offen offset:2048 sc1
    buffer_load_dwordx4 v[24:27], v10, s[12:15], s76 offen offset:3072 sc1
    buffer_load_dwordx4 v[28:31], v10, s[12:15], s77 offen offset:0 sc1
    s_mov_b64 exec, -1
    s_sub_u32 s56, s56, 1
    s_cbranch_scc1 L_exit
    s_waitcnt vmcnt(0)
    v_xor_b32 v11, 1, v12
    v_bitop3_b32 v11, v11, v13, 1 bitop3:0xf6
    v_bitop3_b32 v11, v11, v14, 1 bitop3:0xf6
    v_bitop3_b32 v11, v11, v15, 1 bitop3:0xf6
    v_bitop3_b32 v11, v11, v16, 1 bitop3:0xf6
    v_bitop3_b32 v11, v11, v17, 1 bitop3:0xf6
    v_bitop3_b32 v11, v11, v18, 1 bitop3:0xf6
    v_bitop3_b32 v11, v11, v19, 1 bitop3:0xf6
    v_bitop3_b32 v11, v11, v20, 1 bitop3:0xf6
    v_bitop3_b32 v11, v11, v21, 1 bitop3:0xf6
    v_bitop3_b32 v11, v11, v22, 1 bitop3:0xf6
    v_bitop3_b32 v11, v11, v23, 1 bitop3:0xf6
    v_bitop3_b32 v11, v11, v24, 1 bitop3:0xf6
    v_bitop3_b32 v11, v11, v25, 1 bitop3:0xf6
    v_bitop3_b32 v11, v11, v26, 1 bitop3:0xf6
    v_bitop3_b32 v11, v11, v27, 1 bitop3:0xf6
    v_bitop3_b32 v11, v11, v28, 1 bitop3:0xf6
    v_bitop3_b32 v11, v11, v29, 1 bitop3:0xf6
    v_bitop3_b32 v11, v11, v30, 1 bitop3:0xf6
    v_bitop3_b32 v11, v11, v31, 1 bitop3:0xf6
    v_and_b32 v11, 15, v11
    v_cmp_ne_u32 vcc, 0, v11
    s_cbranch_vccnz L_pr_23
    s_mov_b32 s77, 0x07060302
    v_perm_b32 v12, v13, v12, s77
    v_perm_b32 v13, v15, v14, s77
    v_perm_b32 v14, v17, v16, s77
    v_perm_b32 v15, v19, v18, s77
    v_perm_b32 v16, v21, v20, s77
    v_perm_b32 v17, v23, v22, s77
    v_perm_b32 v18, v25, v24, s77
    v_perm_b32 v19, v27, v26, s77
    v_perm_b32 v20, v29, v28, s77
    v_perm_b32 v21, v31, v30, s77
    s_mul_i32 s76, s42, 2560
    v_lshl_add_u32 v10, v0, 3, s76
    ds_write_b64 v10, v[12:13] offset:0
    ds_write_b64 v10, v[14:15] offset:512
    ds_write_b64 v10, v[16:17] offset:1024
    ds_write_b64 v10, v[18:19] offset:1536
    ds_write_b64 v10, v[20:21] offset:2048
L_n_21:
    s_lshl_b32 s84, s54, 11
    s_lshl_b32 s78, s42, 9
    s_add_u32 s84, s84, s78
    s_add_u32 s84, s84, 0x2a8000
    v_and_b32 v7, 31, v0
    v_lshlrev_b32 v7, 4, v7
    v_bfe_u32 v8, v0, 3, 2
    v_and_b32 v9, 7, v0
    v_min_u32 v9, 6, v9
    v_lshlrev_b32 v9, 2, v9
    v_mad_u32_u24 v8, v8, 28, v9
    s_mul_i32 s77, s54, 896
    s_mul_i32 s76, s42, 224
    s_add_u32 s77, s77, s76
    v_lshl_add_u32 v8, v8, 1, s77
    global_load_dwordx2 v[28:29], v8, s[16:17]
    s_lshl_b32 s76, s54, 14
    s_add_u32 s76, s76, 0x260000
    s_add_u32 s76, s76, s78
    s_add_u32 s77, s76, 4096
    v_lshrrev_b32 v9, 5, v0
    v_lshl_add_u32 v9, v9, 13, v7
    s_waitcnt lgkmcnt(0)
    s_barrier
    s_sleep 4
    s_branch L_pf_26
L_pr_25:
    s_mov_b64 exec, vcc
L_pf_26:
    buffer_load_dwordx4 v[10:13], v9, s[12:15], s76 offen offset:0 sc1
    buffer_load_dwordx4 v[14:17], v9, s[12:15], s76 offen offset:2048 sc1
    buffer_load_dwordx4 v[18:21], v9, s[12:15], s77 offen offset:0 sc1
    buffer_load_dwordx4 v[22:25], v9, s[12:15], s77 offen offset:2048 sc1
    s_mov_b64 exec, -1
    s_sub_u32 s56, s56, 1
    s_cbranch_scc1 L_exit
    s_waitcnt vmcnt(0)
    v_xor_b32 v8, 1, v10
    v_bitop3_b32 v8, v8, v11, 1 bitop3:0xf6
    v_bitop3_b32 v8, v8, v12, 1 bitop3:0xf6
    v_bitop3_b32 v8, v8, v13, 1 bitop3:0xf6
    v_bitop3_b32 v8, v8, v14, 1 bitop3:0xf6
    v_bitop3_b32 v8, v8, v15, 1 bitop3:0xf6
    v_bitop3_b32 v8, v8, v16, 1 bitop3:0xf6
    v_bitop3_b32 v8, v8, v17, 1 bitop3:0xf6
    v_bitop3_b32 v8, v8, v18, 1 bitop3:0xf6
    v_bitop3_b32 v8, v8, v19, 1 bitop3:0xf6
    v_bitop3_b32 v8, v8, v20, 1 bitop3:0xf6
    v_bitop3_b32 v8, v8, v21, 1 bitop3:0xf6
    v_bitop3_b32 v8, v8, v22, 1 bitop3:0xf6
    v_bitop3_b32 v8, v8, v23, 1 bitop3:0xf6
    v_bitop3_b32 v8, v8, v24, 1 bitop3:0xf6
    v_bitop3_b32 v8, v8, v25, 1 bitop3:0xf6
    v_and_b32 v8, 15, v8
    v_cmp_ne_u32 vcc, 0, v8
    s_cbranch_vccnz L_pr_25
    s_add_u32 s47, s47, 0x4000000
    s_cmp_gt_u32 s54, 5
    s_nop 0
    s_cbranch_scc1 L_n_27
    s_mov_b32 s71, 0
    s_mov_b32 s89, 4
    s_call_b64 s[74:75], L_pieces
L_n_27:
    v_pk_add_f32 v[10:11], v[10:11], v[14:15]
    v_pk_add_f32 v[12:13], v[12:13], v[16:17]
    v_pk_add_f32 v[18:19], v[18:19], v[22:23]
    v_pk_add_f32 v[20:21], v[20:21], v[24:25]
    v_pk_add_f32 v[10:11], v[10:11], v[18:19]
    v_pk_add_f32 v[12:13], v[12:13], v[20:21]
    v_and_b32 v31, 0xffff0000, v29
    v_lshlrev_b32 v30, 16, v29
    v_and_b32 v29, 0xffff0000, v28
    v_lshlrev_b32 v28, 16, v28
    v_mov_b32 v14, v10
    v_mov_b32 v15, v11
    v_mov_b32 v16, v12
    v_mov_b32 v17, v13
    v_permlane32_swap_b32 v10, v14
    v_permlane32_swap_b32 v11, v15
    v_permlane32_swap_b32 v12, v16
    v_permlane32_swap_b32 v13, v17
    v_add_f32 v10, v10, v14
    v_add_f32 v11, v11, v15
    v_add_f32 v12, v12, v16
    v_add_f32 v13, v13, v17
    v_cvt_pk_bf16_f32 v11, v10, v11
    v_cvt_pk_bf16_f32 v13, v12, v13
    v_lshlrev_b32 v10, 16, v11
    v_and_b32 v11, 0xffff0000, v11
    v_lshlrev_b32 v12, 16, v13
    v_and_b32 v13, 0xffff0000, v13
    v_pk_add_f32 v[10:11], v[10:11], v[28:29]
    v_pk_add_f32 v[12:13], v[12:13], v[30:31]
    v_cvt_pk_bf16_f32 v11, v10, v11
    v_cvt_pk_bf16_f32 v13, v12, v13
    v_lshlrev_b32 v10, 16, v11
    v_and_b32 v11, 0xffff0000, v11
    v_lshlrev_b32 v12, 16, v13
    v_and_b32 v13, 0xffff0000, v13
    s_xor_b32 s60, s60, 64
    v_readlane_b32 s79, v10, 0
    s_mov_b32 vcc_lo, 0x7f7f7f7f
    s_mov_b32 vcc_hi, 0x7f7f7f7f
    s_lshl4_add_u32 s78, s42, s60
    v_subrev_f32 v14, s79, v10
    v_subrev_f32 v15, s79, v11
    v_subrev_f32 v16, s79, v12
    v_subrev_f32 v17, s79, v13
    v_mov_b32 v22, s78
    v_pk_mul_f32 v[20:21], v[14:15], v[14:15]
    v_pk_add_f32 v[18:19], v[14:15], v[16:17]
    v_pk_fma_f32 v[20:21], v[16:17], v[16:17], v[20:21]
    v_add_f32 v18, v18, v19
    v_and_b32 v23, 3, v0
    v_add_f32 v19, v20, v21
    v_mov_b32 v20, s79
    v_cndmask_b32 v18, 0, v18, vcc
    v_cndmask_b32 v19, 0, v19, vcc
    v_lshl_add_u32 v23, v23, 4, s60
    v_add_f32_dpp v18, v18, v18 quad_perm:[1,0,3,2] row_mask:0xf bank_mask:0xf
    v_add_f32_dpp v19, v19, v19 quad_perm:[1,0,3,2] row_mask:0xf bank_mask:0xf
    s_nop 0
    v_add_f32_dpp v18, v18, v18 quad_perm:[2,3,0,1] row_mask:0xf bank_mask:0xf
    v_add_f32_dpp v19, v19, v19 quad_perm:[2,3,0,1] row_mask:0xf bank_mask:0xf
    s_nop 0
    v_add_f32_dpp v18, v18, v18 row_half_mirror row_mask:0xf bank_mask:0xf
    v_add_f32_dpp v19, v19, v19 row_half_mirror row_mask:0xf bank_mask:0xf
    s_nop 0
    v_add_f32_dpp v18, v18, v18 row_mirror row_mask:0xf bank_mask:0xf
    v_add_f32_dpp v19, v19, v19 row_mirror row_mask:0xf bank_mask:0xf
    s_nop 0
    v_add_f32_dpp v18, v18, v18 row_bcast:15 row_mask:0xa bank_mask:0xf
    v_add_f32_dpp v19, v19, v19 row_bcast:15 row_mask:0xa bank_mask:0xf
    s_mov_b32 exec_lo, 0x80000000
    s_mov_b32 exec_hi, 0
    ds_write_b128 v22, v[18:21] offset:10304
    s_mov_b64 exec, -1
    v_mov_b32 v24, 0x42e00000
    s_waitcnt lgkmcnt(0)
    s_barrier
    ds_read_b128 v[14:17], v23 offset:10304
    s_waitcnt lgkmcnt(0)
    v_fma_f32 v26, v16, v24, v14
    v_mul_f32 v14, -2.0, v14
    s_nop 0
    v_add_f32_dpp v26, v26, v26 quad_perm:[1,0,3,2] row_mask:0xf bank_mask:0xf
    s_nop 1
    v_add_f32_dpp v26, v26, v26 quad_perm:[2,3,0,1] row_mask:0xf bank_mask:0xf
    v_mul_f32 v26, 0x3b124925, v26
    v_sub_f32 v16, v26, v16
    v_fmac_f32 v14, v16, v24
    v_fmac_f32 v15, v16, v14
    s_nop 1
    v_add_f32_dpp v15, v15, v15 quad_perm:[1,0,3,2] row_mask:0xf bank_mask:0xf
    s_nop 1
    v_add_f32_dpp v15, v15, v15 quad_perm:[2,3,0,1] row_mask:0xf bank_mask:0xf
    v_mul_f32 v27, 0x3b124925, v15
    v_max_f32 v27, 0, v27
    v_cvt_pk_bf16_f32 v29, v26, v27
    v_lshlrev_b32 v28, 16, v29
    v_and_b32 v29, 0xffff0000, v29
    v_add_f32 v29, 0x3727c5ac, v29
    v_cvt_pk_bf16_f32 v29, v29, v29
    v_lshlrev_b32 v29, 16, v29
    v_sqrt_f32 v29, v29
    s_nop 0
    v_cvt_pk_bf16_f32 v29, v29, v29
    v_lshlrev_b32 v29, 16, v29
    v_rcp_f32 v29, v29
    v_sub_f32 v26, v26, v28
    v_mul_f32 v27, v27, v29
    v_mul_f32 v26, v26, v29
    v_mul_f32 v27, v27, v29
    v_pk_add_f32 v[18:19], v[10:11], v[28:29] op_sel_hi:[1,0] neg_lo:[0,1] neg_hi:[0,1]
    v_pk_add_f32 v[20:21], v[12:13], v[28:29] op_sel_hi:[1,0] neg_lo:[0,1] neg_hi:[0,1]
    v_cvt_pk_bf16_f32 v19, v18, v19
    v_cvt_pk_bf16_f32 v21, v20, v21
    v_lshlrev_b32 v18, 16, v19
    v_and_b32 v19, 0xffff0000, v19
    v_lshlrev_b32 v20, 16, v21
    v_and_b32 v21, 0xffff0000, v21
    v_pk_mul_f32 v[18:19], v[18:19], v[28:29] op_sel:[0,1] op_sel_hi:[1,1]
    v_pk_mul_f32 v[20:21], v[20:21], v[28:29] op_sel:[0,1] op_sel_hi:[1,1]
    v_cvt_pk_bf16_f32 v19, v18, v19
    v_cvt_pk_bf16_f32 v21, v20, v21
    v_lshlrev_b32 v18, 16, v19
    v_and_b32 v19, 0xffff0000, v19
    v_lshlrev_b32 v20, 16, v21
    v_and_b32 v21, 0xffff0000, v21
    v_cvt_pk_bf16_f32 v29, v26, v27
    v_lshlrev_b32 v28, 16, v29
    v_and_b32 v29, 0xffff0000, v29
    v_add_f32 v29, 0x3727c5ac, v29
    v_cvt_pk_bf16_f32 v29, v29, v29
    v_lshlrev_b32 v29, 16, v29
    v_sqrt_f32 v29, v29
    s_nop 0
    v_cvt_pk_bf16_f32 v29, v29, v29
    v_lshlrev_b32 v29, 16, v29
    v_rcp_f32 v29, v29
    s_nop 0
    v_pk_add_f32 v[18:19], v[18:19], v[28:29] op_sel_hi:[1,0] neg_lo:[0,1] neg_hi:[0,1]
    v_pk_add_f32 v[20:21], v[20:21], v[28:29] op_sel_hi:[1,0] neg_lo:[0,1] neg_hi:[0,1]
    v_cvt_pk_bf16_f32 v19, v18, v19
    v_cvt_pk_bf16_f32 v21, v20, v21
    v_lshlrev_b32 v18, 16, v19
    v_and_b32 v19, 0xffff0000, v19
    v_lshlrev_b32 v20, 16, v21
    v_and_b32 v21, 0xffff0000, v21
    v_pk_mul_f32 v[18:19], v[18:19], v[28:29] op_sel:[0,1] op_sel_hi:[1,1]
    v_pk_mul_f32 v[20:21], v[20:21], v[28:29] op_sel:[0,1] op_sel_hi:[1,1]
    v_cvt_pk_bf16_f32 v19, v18, v19
    v_cvt_pk_bf16_f32 v21, v20, v21
    v_lshlrev_b32 v18, 16, v19
    v_and_b32 v19, 0xffff0000, v19
    v_lshlrev_b32 v20, 16, v21
    v_and_b32 v21, 0xffff0000, v21
    v_lshrrev_b32 v22, 31, v18
    v_lshrrev_b32 v23, 31, v19
    v_lshrrev_b32 v24, 31, v20
    v_lshrrev_b32 v25, 31, v21
    v_bfe_u32 v18, v18, 14, 17
    v_bfe_u32 v19, v19, 14, 17
    v_bfe_u32 v20, v20, 14, 17
    v_bfe_u32 v21, v21, 14, 17
    v_lshl_add_u32 v18, v22, 1, v18
    v_lshl_add_u32 v19, v23, 1, v19
    v_lshl_add_u32 v20, v24, 1, v20
    v_lshl_add_u32 v21, v25, 1, v21
    v_subrev_u32 v18, 56832, v18
    v_subrev_u32 v19, 56832, v19
    v_subrev_u32 v20, 56832, v20
    v_subrev_u32 v21, 56832, v21
    v_min_u32 v22, 10238, v18
    v_min_u32 v23, 10238, v19
    v_min_u32 v24, 10238, v20
    v_min_u32 v25, 10238, v21
    ds_read_u16 v22, v22 offset:0
    ds_read_u16 v23, v23 offset:0
    ds_read_u16 v24, v24 offset:0
    ds_read_u16 v25, v25 offset:0
    v_max3_u32 v8, v18, v19, v20
    v_max_u32 v8, v8, v21
    v_cmp_lt_u32 vcc, 10239, v8
    s_waitcnt lgkmcnt(0)
    s_and_b32 s78, vcc_lo, 0x7f7f7f7f
    v_lshlrev_b32 v22, 16, v22
    v_lshlrev_b32 v23, 16, v23
    v_lshlrev_b32 v24, 16, v24
    v_lshlrev_b32 v25, 16, v25
    s_nop 0
    s_cbranch_scc0 L_ok_28
    v_cmp_lt_u32 vcc, 10239, v18
    s_nop 0
    s_and_b32 s78, vcc_lo, 0x7f7f7f7f
L_fb_29:
    s_cmp_eq_u32 s78, 0
    s_nop 0
    s_cbranch_scc1 L_fe_30
    s_ff1_i32_b32 s80, s78
    s_bitset0_b32 s78, s80
    v_readlane_b32 s76, v18, s80
    s_nop 3
    s_call_b64 s[64:65], L_eval
    s_mov_b32 m0, s80
    s_nop 0
    v_writelane_b32 v22, s76, m0
    s_nop 0
    s_branch L_fb_29
L_fe_30:
    v_cmp_lt_u32 vcc, 10239, v19
    s_nop 0
    s_and_b32 s78, vcc_lo, 0x7f7f7f7f
L_fb_31:
    s_cmp_eq_u32 s78, 0
    s_nop 0
    s_cbranch_scc1 L_fe_32
    s_ff1_i32_b32 s80, s78
    s_bitset0_b32 s78, s80
    v_readlane_b32 s76, v19, s80
    s_nop 3
    s_call_b64 s[64:65], L_eval
    s_mov_b32 m0, s80
    s_nop 0
    v_writelane_b32 v23, s76, m0
    s_nop 0
    s_branch L_fb_31
L_fe_32:
    v_cmp_lt_u32 vcc, 10239, v20
    s_nop 0
    s_and_b32 s78, vcc_lo, 0x7f7f7f7f
L_fb_33:
    s_cmp_eq_u32 s78, 0
    s_nop 0
    s_cbranch_scc1 L_fe_34
    s_ff1_i32_b32 s80, s78
    s_bitset0_b32 s78, s80
    v_readlane_b32 s76, v20, s80
    s_nop 3
    s_call_b64 s[64:65], L_eval
    s_mov_b32 m0, s80
    s_nop 0
    v_writelane_b32 v24, s76, m0
    s_nop 0
    s_branch L_fb_33
L_fe_34:
    v_cmp_lt_u32 vcc, 10239, v21
    s_nop 0
    s_and_b32 s78, vcc_lo, 0x7f7f7f7f
L_fb_35:
    s_cmp_eq_u32 s78, 0
    s_nop 0
    s_cbranch_scc1 L_fe_36
    s_ff1_i32_b32 s80, s78
    s_bitset0_b32 s78, s80
    v_readlane_b32 s76, v21, s80
    s_nop 3
    s_call_b64 s[64:65], L_eval
    s_mov_b32 m0, s80
    s_nop 0
    v_writelane_b32 v25, s76, m0
    s_nop 0
    s_branch L_fb_35
L_fe_36:
    v_mov_b32 v8, v7
    v_lshrrev_b32 v6, 4, v0
    v_bfe_u32 v7, v0, 2, 2
    v_lshl_add_u32 v6, v6, 3, v7
    v_and_b32 v7, 3, v0
    v_lshlrev_b32 v7, 3, v7
    v_lshl_add_u32 v6, v6, 6, v7
    v_add_u32 v6, s48, v6
    ds_read_b64_tr_b16 v[32:33], v6 offset:8192
    ds_read_b64_tr_b16 v[34:35], v6 offset:8448
    ds_read_b64_tr_b16 v[36:37], v6 offset:9984
    ds_read_b64_tr_b16 v[38:39], v6 offset:10240
    ds_read_b64_tr_b16 v[40:41], v6 offset:11776
    ds_read_b64_tr_b16 v[42:43], v6 offset:12032
    ds_read_b64_tr_b16 v[44:45], v6 offset:13568
    ds_read_b64_tr_b16 v[46:47], v6 offset:13824
    ds_read_b64_tr_b16 v[48:49], v6 offset:8224
    ds_read_b64_tr_b16 v[50:51], v6 offset:8480
    ds_read_b64_tr_b16 v[52:53], v6 offset:10016
    ds_read_b64_tr_b16 v[54:55], v6 offset:10272
    ds_read_b64_tr_b16 v[56:57], v6 offset:11808
    ds_read_b64_tr_b16 v[58:59], v6 offset:12064
    ds_read_b64_tr_b16 v[60:61], v6 offset:13600
    ds_read_b64_tr_b16 v[62:63], v6 offset:13856
    s_mov_b32 vcc_lo, -1
    s_mov_b32 vcc_hi, 0x0000ffff
    s_waitcnt lgkmcnt(0)
    v_cndmask_b32 v46, 0, v46, vcc
    v_cndmask_b32 v47, 0, v47, vcc
    v_cndmask_b32 v62, 0, v62, vcc
    v_cndmask_b32 v63, 0, v63, vcc
    v_mov_b32 v7, v8
L_ok_28:
    v_pk_add_f32 v[10:11], v[10:11], v[22:23]
    v_pk_add_f32 v[12:13], v[12:13], v[24:25]
    v_cvt_pk_bf16_f32 v11, v10, v11
    v_cvt_pk_bf16_f32 v13, v12, v13
    v_lshlrev_b32 v10, 16, v11
    v_and_b32 v11, 0xffff0000, v11
    v_lshlrev_b32 v12, 16, v13
    v_and_b32 v13, 0xffff0000, v13
    s_cmp_lg_u32 s26, s54
    s_cbranch_scc1 L_n_37
    s_mov_b32 exec_hi, 0
    buffer_store_dwordx4 v[10:13], v7, s[12:15], s84 offen sc1
    s_mov_b64 exec, -1
L_n_37:
    s_xor_b32 s60, s60, 64
    v_readlane_b32 s79, v10, 0
    s_mov_b32 vcc_lo, 0x7f7f7f7f
    s_mov_b32 vcc_hi, 0x7f7f7f7f
    s_lshl4_add_u32 s78, s42, s60
    v_subrev_f32 v14, s79, v10
    v_subrev_f32 v15, s79, v11
    v_subrev_f32 v16, s79, v12
    v_subrev_f32 v17, s79, v13
    v_mov_b32 v22, s78
    v_pk_mul_f32 v[20:21], v[14:15], v[14:15]
    v_pk_add_f32 v[18:19], v[14:15], v[16:17]
    v_pk_fma_f32 v[20:21], v[16:17], v[16:17], v[20:21]
    v_add_f32 v18, v18, v19
    v_and_b32 v23, 3, v0
    v_add_f32 v19, v20, v21
    v_mov_b32 v20, s79
    v_cndmask_b32 v18, 0, v18, vcc
    v_cndmask_b32 v19, 0, v19, vcc
    v_lshl_add_u32 v23, v23, 4, s60
    v_add_f32_dpp v18, v18, v18 quad_perm:[1,0,3,2] row_mask:0xf bank_mask:0xf
    v_add_f32_dpp v19, v19, v19 quad_perm:[1,0,3,2] row_mask:0xf bank_mask:0xf
    s_nop 0
    v_add_f32_dpp v18, v18, v18 quad_perm:[2,3,0,1] row_mask:0xf bank_mask:0xf
    v_add_f32_dpp v19, v19, v19 quad_perm:[2,3,0,1] row_mask:0xf bank_mask:0xf
    s_nop 0
    v_add_f32_dpp v18, v18, v18 row_half_mirror row_mask:0xf bank_mask:0xf
    v_add_f32_dpp v19, v19, v19 row_half_mirror row_mask:0xf bank_mask:0xf
    s_nop 0
    v_add_f32_dpp v18, v18, v18 row_mirror row_mask:0xf bank_mask:0xf
    v_add_f32_dpp v19, v19, v19 row_mirror row_mask:0xf bank_mask:0xf
    s_nop 0
    v_add_f32_dpp v18, v18, v18 row_bcast:15 row_mask:0xa bank_mask:0xf
    v_add_f32_dpp v19, v19, v19 row_bcast:15 row_mask:0xa bank_mask:0xf
    s_mov_b32 exec_lo, 0x80000000
    s_mov_b32 exec_hi, 0
    ds_write_b128 v22, v[18:21] offset:10304
    s_mov_b64 exec, -1
    v_mov_b32 v24, 0x42e00000
    s_waitcnt lgkmcnt(0)
    s_barrier
    ds_read_b128 v[14:17], v23 offset:10304
    s_waitcnt lgkmcnt(0)
    v_fma_f32 v26, v16, v24, v14
    v_mul_f32 v14, -2.0, v14
    s_nop 0
    v_add_f32_dpp v26, v26, v26 quad_perm:[1,0,3,2] row_mask:0xf bank_mask:0xf
    s_nop 1
    v_add_f32_dpp v26, v26, v26 quad_perm:[2,3,0,1] row_mask:0xf bank_mask:0xf
    v_mul_f32 v26, 0x3b124925, v26
    v_sub_f32 v16, v26, v16
    v_fmac_f32 v14, v16, v24
    v_fmac_f32 v15, v16, v14
    s_nop 1
    v_add_f32_dpp v15, v15, v15 quad_perm:[1,0,3,2] row_mask:0xf bank_mask:0xf
    s_nop 1
    v_add_f32_dpp v15, v15, v15 quad_perm:[2,3,0,1] row_mask:0xf bank_mask:0xf
    v_mul_f32 v27, 0x3b124925, v15
    v_max_f32 v27, 0, v27
    v_cvt_pk_bf16_f32 v29, v26, v27
    v_lshlrev_b32 v28, 16, v29
    v_and_b32 v29, 0xffff0000, v29
    v_add_f32 v29, 0x3727c5ac, v29
    v_cvt_pk_bf16_f32 v29, v29, v29
    v_lshlrev_b32 v29, 16, v29
    v_sqrt_f32 v29, v29
    s_nop 0
    v_cvt_pk_bf16_f32 v29, v29, v29
    v_lshlrev_b32 v29, 16, v29
    v_rcp_f32 v29, v29
    s_nop 0
    v_pk_add_f32 v[14:15], v[10:11], v[28:29] op_sel_hi:[1,0] neg_lo:[0,1] neg_hi:[0,1]
    v_pk_add_f32 v[16:17], v[12:13], v[28:29] op_sel_hi:[1,0] neg_lo:[0,1] neg_hi:[0,1]
    v_cvt_pk_bf16_f32 v15, v14, v15
    v_cvt_pk_bf16_f32 v17, v16, v17
    v_lshlrev_b32 v14, 16, v15
    v_and_b32 v15, 0xffff0000, v15
    v_lshlrev_b32 v16, 16, v17
    v_and_b32 v17, 0xffff0000, v17
    v_pk_mul_f32 v[14:15], v[14:15], v[28:29] op_sel:[0,1] op_sel_hi:[1,1]
    v_pk_mul_f32 v[16:17], v[16:17], v[28:29] op_sel:[0,1] op_sel_hi:[1,1]
    v_cvt_pk_bf16_f32 v18, v14, v15
    v_cvt_pk_bf16_f32 v19, v16, v17
    s_lshl_b32 s78, s42, 8
    v_lshl_add_u32 v22, v0, 3, s78
    v_cndmask_b32 v18, 0, v18, vcc
    v_cndmask_b32 v19, 0, v19, vcc
    v_and_b32 v23, 48, v0
    v_add_u32 v23, s78, v23
    s_mov_b32 exec_hi, 0
    ds_write_b64 v22, v[18:19] offset:11264
    s_mov_b64 exec, -1
    ds_read_b128 v[6:9], v23 offset:11264
    ds_read_b128 v[10:13], v23 offset:11328
    ds_read_b128 v[14:17], v23 offset:11392
    ds_read_b128 v[18:21], v23 offset:11456
    s_lshl_b32 s76, s54, 14
    s_add_u32 s76, s76, 0x240000
    s_add_u32 s76, s76, s53
    s_lshl_b32 s78, s42, 7
    v_lshl_add_u32 v22, v0, 2, s78
    s_waitcnt lgkmcnt(3)
    v_mfma_f32_16x16x32_bf16 v[24:27], v[6:9], v[32:35], 0
    v_mfma_f32_16x16x32_bf16 v[28:31], v[6:9], v[48:51], 0
    s_waitcnt lgkmcnt(2)
    v_mfma_f32_16x16x32_bf16 v[24:27], v[10:13], v[36:39], v[24:27]
    v_mfma_f32_16x16x32_bf16 v[28:31], v[10:13], v[52:55], v[28:31]
    s_waitcnt lgkmcnt(1)
    v_mfma_f32_16x16x32_bf16 v[24:27], v[14:17], v[40:43], v[24:27]
    v_mfma_f32_16x16x32_bf16 v[28:31], v[14:17], v[56:59], v[28:31]
    s_waitcnt lgkmcnt(0)
    v_mfma_f32_16x16x32_bf16 v[24:27], v[18:21], v[44:47], v[24:27]
    v_mfma_f32_16x16x32_bf16 v[28:31], v[18:21], v[60:63], v[28:31]
    s_mov_b64 exec, 0xffff
    v_add_u32 v22, 10432, v22
    s_nop 5
    ds_write2_b32 v22, v24, v28 offset0:0 offset1:16
    s_mov_b64 exec, -1
    v_lshlrev_b32 v10, 2, v0
    v_and_b32 v11, 124, v10
    v_add_u32 v11, 10432, v11
    s_waitcnt lgkmcnt(0)
    s_barrier
    buffer_load_dword v8, off, s[12:15], s70 sc1
    s_cmp_lg_u32 s42, 0
    s_cbranch_scc1 L_o_38
    ds_read2_b32 v[12:13], v11 offset0:0 offset1:32
    ds_read2_b32 v[14:15], v11 offset0:64 offset1:96
    s_waitcnt lgkmcnt(0)
    v_pk_add_f32 v[12:13], v[12:13], v[14:15]
    v_add_f32 v12, v12, v13
    v_cvt_pk_bf16_f32 v11, v12, v12
    v_lshl_or_b32 v11, v11, 16, 1
    s_mov_b32 exec_hi, 0
    s_cmp_eq_u32 s50, 0
    s_cbranch_scc1 L_g_39
    buffer_store_dword v11, v10, s[12:15], s76 offen
    s_branch L_e_40
L_g_39:
    buffer_store_dword v11, v10, s[12:15], s76 offen sc1
L_e_40:
    s_mov_b64 exec, -1
    s_lshl_b32 s76, s54, 14
    s_add_u32 s76, s76, 0x240000
    s_lshl_b32 s77, s43, 11
    s_add_u32 s76, s76, s77
    v_lshlrev_b32 v10, 4, v0
    s_nop 0
    s_branch L_pf_42
L_pr_41:
    s_mov_b64 exec, vcc
L_pf_42:
    buffer_load_dwordx4 v[12:15], v10, s[12:15], s76 offen sc1
    buffer_load_dwordx4 v[16:19], v10, s[12:15], s76 offen offset:1024 sc1
    s_mov_b64 exec, -1
    s_sub_u32 s56, s56, 1
    s_cbranch_scc1 L_exit
    s_waitcnt vmcnt(0)
    v_xor_b32 v11, 1, v12
    v_bitop3_b32 v11, v11, v13, 1 bitop3:0xf6
    v_bitop3_b32 v11, v11, v14, 1 bitop3:0xf6
    v_bitop3_b32 v11, v11, v15, 1 bitop3:0xf6
    v_bitop3_b32 v11, v11, v16, 1 bitop3:0xf6
    v_bitop3_b32 v11, v11, v17, 1 bitop3:0xf6
    v_bitop3_b32 v11, v11, v18, 1 bitop3:0xf6
    v_bitop3_b32 v11, v11, v19, 1 bitop3:0xf6
    v_and_b32 v11, 15, v11
    v_cmp_ne_u32 vcc, 0, v11
    s_cbranch_vccnz L_pr_41
    s_mov_b32 s77, 0x07060302
    v_perm_b32 v20, v13, v12, s77
    v_perm_b32 v21, v15, v14, s77
    v_perm_b32 v22, v17, v16, s77
    v_perm_b32 v23, v19, v18, s77
    v_lshlrev_b32 v10, 3, v0
    v_add_u32 v10, 13312, v10
    ds_write_b64 v10, v[20:21]
    ds_write_b64 v10, v[22:23] offset:512
L_o_38:
L_nc:
    v_and_b32 v9, 1, v0
    v_and_b32 v3, 48, v0
    v_lshl_add_u32 v9, v9, 9, v3
    s_waitcnt vmcnt(0)
    s_waitcnt lgkmcnt(0)
    s_barrier
    v_readfirstlane_b32 s76, v8
    s_add_u32 s77, s54, 2
    s_cmp_ge_u32 s76, s77
    s_cselect_b32 s72, 1, 1
    s_cmp_gt_u32 s54, 5
    s_cselect_b32 s72, 0, s72
    s_cmp_eq_u32 s72, 0
    s_cbranch_scc1 L_p1_43
    ds_read_b128 v[44:47], v9 offset:13312
    ds_read_b128 v[48:51], v9 offset:13376
    ds_read_b128 v[52:55], v9 offset:13440
    ds_read_b128 v[56:59], v9 offset:13504
    s_add_u32 m0, s48, 4096
    v_xor_b32 v3, 0x4080, v1
    buffer_load_dwordx4 v3, s[4:7], s47 offen nt lds
    s_add_u32 m0, s48, 5120
    v_xor_b32 v3, 0x50a0, v1
    buffer_load_dwordx4 v3, s[4:7], s47 offen nt lds
    s_add_u32 m0, s48, 6144
    v_xor_b32 v3, 0x60c0, v1
    buffer_load_dwordx4 v3, s[4:7], s47 offen nt lds
    s_add_u32 m0, s48, 7168
    v_xor_b32 v3, 0x70e0, v1
    buffer_load_dwordx4 v3, s[4:7], s47 offen nt lds
    s_add_u32 m0, s48, 8192
    v_xor_b32 v3, 0x8000, v1
    buffer_load_dwordx4 v3, s[4:7], s47 offen nt lds
    s_add_u32 m0, s48, 9216
    v_xor_b32 v3, 0x9020, v1
    buffer_load_dwordx4 v3, s[4:7], s47 offen nt lds
    s_waitcnt lgkmcnt(3)
    v_mfma_f32_16x16x32_bf16 v[12:15], a[0:3], v[44:47], 0
    v_mfma_f32_16x16x32_bf16 v[16:19], a[32:35], v[44:47], 0
    v_mfma_f32_16x16x32_bf16 v[20:23], a[64:67], v[44:47], 0
    v_mfma_f32_16x16x32_bf16 v[24:27], a[96:99], v[44:47], 0
    v_mfma_f32_16x16x32_bf16 v[28:31], a[128:131], v[44:47], 0
    v_mfma_f32_16x16x32_bf16 v[32:35], a[160:163], v[44:47], 0
    v_mfma_f32_16x16x32_bf16 v[36:39], a[192:195], v[44:47], 0
    v_mfma_f32_16x16x32_bf16 v[40:43], a[224:227], v[44:47], 0
    ds_read_b128 v[44:47], v9 offset:13568
    s_waitcnt lgkmcnt(3)
    v_mfma_f32_16x16x32_bf16 v[12:15], a[4:7], v[48:51], v[12:15]
    v_mfma_f32_16x16x32_bf16 v[16:19], a[36:39], v[48:51], v[16:19]
    v_mfma_f32_16x16x32_bf16 v[20:23], a[68:71], v[48:51], v[20:23]
    v_mfma_f32_16x16x32_bf16 v[24:27], a[100:103], v[48:51], v[24:27]
    v_mfma_f32_16x16x32_bf16 v[28:31], a[132:135], v[48:51], v[28:31]
    v_mfma_f32_16x16x32_bf16 v[32:35], a[164:167], v[48:51], v[32:35]
    v_mfma_f32_16x16x32_bf16 v[36:39], a[196:199], v[48:51], v[36:39]
    v_mfma_f32_16x16x32_bf16 v[40:43], a[228:231], v[48:51], v[40:43]
    ds_read_b128 v[48:51], v9 offset:13632
    s_waitcnt lgkmcnt(3)
    v_mfma_f32_16x16x32_bf16 v[12:15], a[8:11], v[52:55], v[12:15]
    v_mfma_f32_16x16x32_bf16 v[16:19], a[40:43], v[52:55], v[16:19]
    v_mfma_f32_16x16x32_bf16 v[20:23], a[72:75], v[52:55], v[20:23]
    v_mfma_f32_16x16x32_bf16 v[24:27], a[104:107], v[52:55], v[24:27]
    v_mfma_f32_16x16x32_bf16 v[28:31], a[136:139], v[52:55], v[28:31]
    v_mfma_f32_16x16x32_bf16 v[32:35], a[168:171], v[52:55], v[32:35]
    v_mfma_f32_16x16x32_bf16 v[36:39], a[200:203], v[52:55], v[36:39]
    v_mfma_f32_16x16x32_bf16 v[40:43], a[232:235], v[52:55], v[40:43]
    ds_read_b128 v[52:55], v9 offset:13696
    s_waitcnt lgkmcnt(3)
    v_mfma_f32_16x16x32_bf16 v[12:15], a[12:15], v[56:59], v[12:15]
    v_mfma_f32_16x16x32_bf16 v[16:19], a[44:47], v[56:59], v[16:19]
    v_mfma_f32_16x16x32_bf16 v[20:23], a[76:79], v[56:59], v[20:23]
    v_mfma_f32_16x16x32_bf16 v[24:27], a[108:111], v[56:59], v[24:27]
    v_mfma_f32_16x16x32_bf16 v[28:31], a[140:143], v[56:59], v[28:31]
    v_mfma_f32_16x16x32_bf16 v[32:35], a[172:175], v[56:59], v[32:35]
    v_mfma_f32_16x16x32_bf16 v[36:39], a[204:207], v[56:59], v[36:39]
    v_mfma_f32_16x16x32_bf16 v[40:43], a[236:239], v[56:59], v[40:43]
    ds_read_b128 v[56:59], v9 offset:13760
    s_waitcnt lgkmcnt(3)
    v_mfma_f32_16x16x32_bf16 v[12:15], a[16:19], v[44:47], v[12:15]
    v_mfma_f32_16x16x32_bf16 v[16:19], a[48:51], v[44:47], v[16:19]
    v_mfma_f32_16x16x32_bf16 v[20:23], a[80:83], v[44:47], v[20:23]
    v_mfma_f32_16x16x32_bf16 v[24:27], a[112:115], v[44:47], v[24:27]
    v_mfma_f32_16x16x32_bf16 v[28:31], a[144:147], v[44:47], v[28:31]
    v_mfma_f32_16x16x32_bf16 v[32:35], a[176:179], v[44:47], v[32:35]
    v_mfma_f32_16x16x32_bf16 v[36:39], a[208:211], v[44:47], v[36:39]
    v_mfma_f32_16x16x32_bf16 v[40:43], a[240:243], v[44:47], v[40:43]
    s_waitcnt lgkmcnt(2)
    v_mfma_f32_16x16x32_bf16 v[12:15], a[20:23], v[48:51], v[12:15]
    v_mfma_f32_16x16x32_bf16 v[16:19], a[52:55], v[48:51], v[16:19]
    v_mfma_f32_16x16x32_bf16 v[20:23], a[84:87], v[48:51], v[20:23]
    v_mfma_f32_16x16x32_bf16 v[24:27], a[116:119], v[48:51], v[24:27]
    v_mfma_f32_16x16x32_bf16 v[28:31], a[148:151], v[48:51], v[28:31]
    s_add_u32 m0, s48, 10240
    v_xor_b32 v3, 0xa040, v1
    buffer_load_dwordx4 v3, s[4:7], s47 offen nt lds
    v_mfma_f32_16x16x32_bf16 v[32:35], a[180:183], v[48:51], v[32:35]
    v_mfma_f32_16x16x32_bf16 v[36:39], a[212:215], v[48:51], v[36:39]
    v_mfma_f32_16x16x32_bf16 v[40:43], a[244:247], v[48:51], v[40:43]
    s_waitcnt lgkmcnt(1)
    v_mfma_f32_16x16x32_bf16 v[12:15], a[24:27], v[52:55], v[12:15]
    v_mfma_f32_16x16x32_bf16 v[16:19], a[56:59], v[52:55], v[16:19]
    v_mfma_f32_16x16x32_bf16 v[20:23], a[88:91], v[52:55], v[20:23]
    v_mfma_f32_16x16x32_bf16 v[24:27], a[120:123], v[52:55], v[24:27]
    v_mfma_f32_16x16x32_bf16 v[28:31], a[152:155], v[52:55], v[28:31]
    v_mfma_f32_16x16x32_bf16 v[32:35], a[184:187], v[52:55], v[32:35]
    v_mfma_f32_16x16x32_bf16 v[36:39], a[216:219], v[52:55], v[36:39]
    s_add_u32 m0, s48, 11264
    v_xor_b32 v3, 0xb060, v1
    buffer_load_dwordx4 v3, s[4:7], s47 offen nt lds
    v_mfma_f32_16x16x32_bf16 v[40:43], a[248:251], v[52:55], v[40:43]
    s_waitcnt lgkmcnt(0)
    v_mfma_f32_16x16x32_bf16 v[12:15], a[28:31], v[56:59], v[12:15]
    v_mfma_f32_16x16x32_bf16 v[16:19], a[60:63], v[56:59], v[16:19]
    v_mfma_f32_16x16x32_bf16 v[20:23], a[92:95], v[56:59], v[20:23]
    v_mfma_f32_16x16x32_bf16 v[24:27], a[124:127], v[56:59], v[24:27]
    v_mfma_f32_16x16x32_bf16 v[28:31], a[156:159], v[56:59], v[28:31]
    v_mfma_f32_16x16x32_bf16 v[32:35], a[188:191], v[56:59], v[32:35]
    v_mfma_f32_16x16x32_bf16 v[36:39], a[220:223], v[56:59], v[36:39]
    v_mfma_f32_16x16x32_bf16 v[40:43], a[252:255], v[56:59], v[40:43]
    s_nop 0
    v_max3_f32 v10, v12, v13, v14
    s_add_u32 m0, s48, 12288
    v_xor_b32 v3, 0xc080, v1
    buffer_load_dwordx4 v3, s[4:7], s47 offen nt lds
    v_max3_f32 v11, v15, v16, v17
    v_max3_f32 v10, v10, v18, v19
    v_max3_f32 v11, v11, v20, v21
    v_max3_f32 v10, v10, v22, v23
    v_max3_f32 v11, v11, v24, v25
    v_max3_f32 v10, v10, v26, v27
    v_max3_f32 v11, v11, v28, v29
    v_max3_f32 v10, v10, v30, v31
    v_max3_f32 v11, v11, v32, v33
    v_max3_f32 v10, v10, v34, v35
    v_max3_f32 v11, v11, v36, v37
    v_max3_f32 v10, v10, v38, v39
    v_max3_f32 v11, v11, v40, v41
    v_max3_f32 v10, v10, v42, v43
    v_max_f32 v10, v10, v11
    v_mov_b32 v11, v10
    s_nop 1
    v_permlane16_swap_b32 v10, v11
    v_max_f32 v10, v10, v11
    v_mov_b32 v11, v10
    s_nop 1
    v_permlane32_swap_b32 v10, v11
    v_max_f32 v10, v10, v11
    v_mul_f32 v10, s58, v10
    v_mov_b32 v60, s58
    v_pk_fma_f32 v[12:13], v[12:13], v[60:61], v[10:11] op_sel_hi:[1,0,0] neg_lo:[0,0,1] neg_hi:[0,0,1]
    v_pk_fma_f32 v[14:15], v[14:15], v[60:61], v[10:11] op_sel_hi:[1,0,0] neg_lo:[0,0,1] neg_hi:[0,0,1]
    v_pk_fma_f32 v[16:17], v[16:17], v[60:61], v[10:11] op_sel_hi:[1,0,0] neg_lo:[0,0,1] neg_hi:[0,0,1]
    v_pk_fma_f32 v[18:19], v[18:19], v[60:61], v[10:11] op_sel_hi:[1,0,0] neg_lo:[0,0,1] neg_hi:[0,0,1]
    v_pk_fma_f32 v[20:21], v[20:21], v[60:61], v[10:11] op_sel_hi:[1,0,0] neg_lo:[0,0,1] neg_hi:[0,0,1]
    v_pk_fma_f32 v[22:23], v[22:23], v[60:61], v[10:11] op_sel_hi:[1,0,0] neg_lo:[0,0,1] neg_hi:[0,0,1]
    v_pk_fma_f32 v[24:25], v[24:25], v[60:61], v[10:11] op_sel_hi:[1,0,0] neg_lo:[0,0,1] neg_hi:[0,0,1]
    v_pk_fma_f32 v[26:27], v[26:27], v[60:61], v[10:11] op_sel_hi:[1,0,0] neg_lo:[0,0,1] neg_hi:[0,0,1]
    v_pk_fma_f32 v[28:29], v[28:29], v[60:61], v[10:11] op_sel_hi:[1,0,0] neg_lo:[0,0,1] neg_hi:[0,0,1]
    v_pk_fma_f32 v[30:31], v[30:31], v[60:61], v[10:11] op_sel_hi:[1,0,0] neg_lo:[0,0,1] neg_hi:[0,0,1]
    v_pk_fma_f32 v[32:33], v[32:33], v[60:61], v[10:11] op_sel_hi:[1,0,0] neg_lo:[0,0,1] neg_hi:[0,0,1]
    v_pk_fma_f32 v[34:35], v[34:35], v[60:61], v[10:11] op_sel_hi:[1,0,0] neg_lo:[0,0,1] neg_hi:[0,0,1]
    v_pk_fma_f32 v[36:37], v[36:37], v[60:61], v[10:11] op_sel_hi:[1,0,0] neg_lo:[0,0,1] neg_hi:[0,0,1]
    s_add_u32 m0, s48, 13312
    v_xor_b32 v3, 0xd0a0, v1
    buffer_load_dwordx4 v3, s[4:7], s47 offen nt lds
    v_pk_fma_f32 v[38:39], v[38:39], v[60:61], v[10:11] op_sel_hi:[1,0,0] neg_lo:[0,0,1] neg_hi:[0,0,1]
    v_pk_fma_f32 v[40:41], v[40:41], v[60:61], v[10:11] op_sel_hi:[1,0,0] neg_lo:[0,0,1] neg_hi:[0,0,1]
    v_pk_fma_f32 v[42:43], v[42:43], v[60:61], v[10:11] op_sel_hi:[1,0,0] neg_lo:[0,0,1] neg_hi:[0,0,1]
    v_exp_f32 v12, v12
    v_exp_f32 v13, v13
    v_exp_f32 v14, v14
    v_exp_f32 v15, v15
    v_exp_f32 v16, v16
    v_exp_f32 v17, v17
    v_exp_f32 v18, v18
    v_exp_f32 v19, v19
    v_exp_f32 v20, v20
    v_exp_f32 v21, v21
    v_exp_f32 v22, v22
    v_exp_f32 v23, v23
    v_exp_f32 v24, v24
    v_exp_f32 v25, v25
    v_exp_f32 v26, v26
    v_exp_f32 v27, v27
    v_exp_f32 v28, v28
    v_exp_f32 v29, v29
    s_add_u32 m0, s48, 14336
    v_xor_b32 v3, 0xe0c0, v1
    buffer_load_dwordx4 v3, s[4:7], s47 offen nt lds
    v_exp_f32 v30, v30
    v_exp_f32 v31, v31
    v_exp_f32 v32, v32
    v_exp_f32 v33, v33
    v_exp_f32 v34, v34
    v_exp_f32 v35, v35
    v_exp_f32 v36, v36
    v_exp_f32 v37, v37
    v_exp_f32 v38, v38
    v_exp_f32 v39, v39
    v_exp_f32 v40, v40
    v_exp_f32 v41, v41
    v_exp_f32 v42, v42
    v_exp_f32 v43, v43
    v_cvt_pk_bf16_f32 v44, v12, v13
    v_cvt_pk_bf16_f32 v45, v14, v15
    v_cvt_pk_bf16_f32 v46, v16, v17
    v_cvt_pk_bf16_f32 v47, v18, v19
    v_cvt_pk_bf16_f32 v48, v20, v21
    v_cvt_pk_bf16_f32 v49, v22, v23
    v_cvt_pk_bf16_f32 v50, v24, v25
    v_cvt_pk_bf16_f32 v51, v26, v27
    v_cvt_pk_bf16_f32 v52, v28, v29
    v_cvt_pk_bf16_f32 v53, v30, v31
    s_add_u32 m0, s48, 15360
    v_xor_b32 v3, 0xf0e0, v1
    buffer_load_dwordx4 v3, s[4:7], s47 offen nt lds
    v_cvt_pk_bf16_f32 v54, v32, v33
    v_cvt_pk_bf16_f32 v55, v34, v35
    v_cvt_pk_bf16_f32 v56, v36, v37
    v_cvt_pk_bf16_f32 v57, v38, v39
    v_cvt_pk_bf16_f32 v58, v40, v41
    v_cvt_pk_bf16_f32 v59, v42, v43
    v_pk_add_f32 v[12:13], v[12:13], v[28:29]
    v_pk_add_f32 v[14:15], v[14:15], v[30:31]
    v_pk_add_f32 v[16:17], v[16:17], v[32:33]
    v_pk_add_f32 v[18:19], v[18:19], v[34:35]
    v_pk_add_f32 v[20:21], v[20:21], v[36:37]
    v_pk_add_f32 v[22:23], v[22:23], v[38:39]
    v_pk_add_f32 v[24:25], v[24:25], v[40:41]
    v_pk_add_f32 v[26:27], v[26:27], v[42:43]
    v_pk_add_f32 v[12:13], v[12:13], v[20:21]
    v_pk_add_f32 v[14:15], v[14:15], v[22:23]
    v_pk_add_f32 v[16:17], v[16:17], v[24:25]
    v_pk_add_f32 v[18:19], v[18:19], v[26:27]
    v_pk_add_f32 v[12:13], v[12:13], v[16:17]
    v_pk_add_f32 v[14:15], v[14:15], v[18:19]
    v_pk_add_f32 v[12:13], v[12:13], v[14:15]
    v_add_f32 v11, v12, v13
    v_mov_b32 v12, v11
    s_nop 1
    v_permlane16_swap_b32 v11, v12
    v_add_f32 v11, v11, v12
    v_mov_b32 v12, v11
    s_nop 1
    v_permlane32_swap_b32 v11, v12
    v_add_f32 v11, v11, v12
    v_xor_b32 v6, 128, v5
    v_xor_b32 v7, 0x240, v5
    v_xor_b32 v8, 0x2c0, v5
    ds_read_b64_tr_b16 v[28:29], v5 offset:16384
    ds_read_b64_tr_b16 v[30:31], v6 offset:16384
    ds_read_b64_tr_b16 v[32:33], v5 offset:16640
    ds_read_b64_tr_b16 v[34:35], v6 offset:16640
    ds_read_b64_tr_b16 v[36:37], v5 offset:18688
    ds_read_b64_tr_b16 v[38:39], v6 offset:18688
    ds_read_b64_tr_b16 v[40:41], v5 offset:18432
    ds_read_b64_tr_b16 v[42:43], v6 offset:18432
    s_waitcnt lgkmcnt(7)
    v_mfma_f32_4x4x4_16b_bf16 v[12:15], v[56:57], v[28:29], 0 cbsz:4 abid:0
    ds_read_b64_tr_b16 v[28:29], v7 offset:20480
    s_waitcnt lgkmcnt(7)
    v_mfma_f32_4x4x4_16b_bf16 v[16:19], v[56:57], v[30:31], 0 cbsz:4 abid:0
    ds_read_b64_tr_b16 v[30:31], v8 offset:20480
    s_waitcnt lgkmcnt(7)
    v_mfma_f32_4x4x4_16b_bf16 v[20:23], v[56:57], v[32:33], 0 cbsz:4 abid:0
    ds_read_b64_tr_b16 v[32:33], v7 offset:20736
    s_waitcnt lgkmcnt(7)
    v_mfma_f32_4x4x4_16b_bf16 v[24:27], v[56:57], v[34:35], 0 cbsz:4 abid:0
    ds_read_b64_tr_b16 v[34:35], v8 offset:20736
    s_waitcnt lgkmcnt(7)
    v_mfma_f32_4x4x4_16b_bf16 v[12:15], v[56:57], v[36:37], v[12:15] cbsz:4 abid:4
    ds_read_b64_tr_b16 v[36:37], v7 offset:22784
    s_waitcnt lgkmcnt(7)
    v_mfma_f32_4x4x4_16b_bf16 v[16:19], v[56:57], v[38:39], v[16:19] cbsz:4 abid:4
    ds_read_b64_tr_b16 v[38:39], v8 offset:22784
    s_waitcnt lgkmcnt(7)
    v_mfma_f32_4x4x4_16b_bf16 v[20:23], v[56:57], v[40:41], v[20:23] cbsz:4 abid:4
    ds_read_b64_tr_b16 v[40:41], v7 offset:22528
    s_waitcnt lgkmcnt(7)
    v_mfma_f32_4x4x4_16b_bf16 v[24:27], v[56:57], v[42:43], v[24:27] cbsz:4 abid:4
    ds_read_b64_tr_b16 v[42:43], v8 offset:22528
    s_waitcnt lgkmcnt(7)
    v_mfma_f32_4x4x4_16b_bf16 v[12:15], v[56:57], v[28:29], v[12:15] cbsz:4 abid:8
    s_waitcnt lgkmcnt(6)
    v_mfma_f32_4x4x4_16b_bf16 v[16:19], v[56:57], v[30:31], v[16:19] cbsz:4 abid:8
    s_waitcnt lgkmcnt(5)
    v_mfma_f32_4x4x4_16b_bf16 v[20:23], v[56:57], v[32:33], v[20:23] cbsz:4 abid:8
    s_waitcnt lgkmcnt(4)
    v_mfma_f32_4x4x4_16b_bf16 v[24:27], v[56:57], v[34:35], v[24:27] cbsz:4 abid:8
    s_waitcnt lgkmcnt(3)
    v_mfma_f32_4x4x4_16b_bf16 v[12:15], v[56:57], v[36:37], v[12:15] cbsz:4 abid:12
    s_waitcnt lgkmcnt(2)
    v_mfma_f32_4x4x4_16b_bf16 v[16:19], v[56:57], v[38:39], v[16:19] cbsz:4 abid:12
    s_waitcnt lgkmcnt(1)
    v_mfma_f32_4x4x4_16b_bf16 v[20:23], v[56:57], v[40:41], v[20:23] cbsz:4 abid:12
    s_waitcnt lgkmcnt(0)
    v_mfma_f32_4x4x4_16b_bf16 v[24:27], v[56:57], v[42:43], v[24:27] cbsz:4 abid:12
    v_xor_b32 v6, 128, v5
    v_xor_b32 v7, 0x240, v5
    v_xor_b32 v8, 0x2c0, v5
    ds_read_b64_tr_b16 v[28:29], v5 offset:24576
    ds_read_b64_tr_b16 v[30:31], v6 offset:24576
    ds_read_b64_tr_b16 v[32:33], v5 offset:24832
    ds_read_b64_tr_b16 v[34:35], v6 offset:24832
    ds_read_b64_tr_b16 v[36:37], v5 offset:26880
    ds_read_b64_tr_b16 v[38:39], v6 offset:26880
    ds_read_b64_tr_b16 v[40:41], v5 offset:26624
    ds_read_b64_tr_b16 v[42:43], v6 offset:26624
    s_waitcnt lgkmcnt(7)
    v_mfma_f32_4x4x4_16b_bf16 v[12:15], v[58:59], v[28:29], v[12:15] cbsz:4 abid:0
    ds_read_b64_tr_b16 v[28:29], v7 offset:28672
    s_waitcnt lgkmcnt(7)
    v_mfma_f32_4x4x4_16b_bf16 v[16:19], v[58:59], v[30:31], v[16:19] cbsz:4 abid:0
    s_add_u32 m0, s48, 16384
    v_xor_b32 v3, 0x10000, v1
    buffer_load_dwordx4 v3, s[4:7], s47 offen nt lds
    ds_read_b64_tr_b16 v[30:31], v8 offset:28672
    s_waitcnt lgkmcnt(7)
    v_mfma_f32_4x4x4_16b_bf16 v[20:23], v[58:59], v[32:33], v[20:23] cbsz:4 abid:0
    ds_read_b64_tr_b16 v[32:33], v7 offset:28928
    s_waitcnt lgkmcnt(7)
    v_mfma_f32_4x4x4_16b_bf16 v[24:27], v[58:59], v[34:35], v[24:27] cbsz:4 abid:0
    ds_read_b64_tr_b16 v[34:35], v8 offset:28928
    s_waitcnt lgkmcnt(7)
    v_mfma_f32_4x4x4_16b_bf16 v[12:15], v[58:59], v[36:37], v[12:15] cbsz:4 abid:4
    ds_read_b64_tr_b16 v[36:37], v7 offset:30976
    s_waitcnt lgkmcnt(7)
    v_mfma_f32_4x4x4_16b_bf16 v[16:19], v[58:59], v[38:39], v[16:19] cbsz:4 abid:4
    ds_read_b64_tr_b16 v[38:39], v8 offset:30976
    s_waitcnt lgkmcnt(7)
    v_mfma_f32_4x4x4_16b_bf16 v[20:23], v[58:59], v[40:41], v[20:23] cbsz:4 abid:4
    ds_read_b64_tr_b16 v[40:41], v7 offset:30720
    s_waitcnt lgkmcnt(7)
    v_mfma_f32_4x4x4_16b_bf16 v[24:27], v[58:59], v[42:43], v[24:27] cbsz:4 abid:4
    ds_read_b64_tr_b16 v[42:43], v8 offset:30720
    s_waitcnt lgkmcnt(7)
    v_mfma_f32_4x4x4_16b_bf16 v[12:15], v[58:59], v[28:29], v[12:15] cbsz:4 abid:8
    s_waitcnt lgkmcnt(6)
    v_mfma_f32_4x4x4_16b_bf16 v[16:19], v[58:59], v[30:31], v[16:19] cbsz:4 abid:8
    s_waitcnt lgkmcnt(5)
    v_mfma_f32_4x4x4_16b_bf16 v[20:23], v[58:59], v[32:33], v[20:23] cbsz:4 abid:8
    s_waitcnt lgkmcnt(4)
    v_mfma_f32_4x4x4_16b_bf16 v[24:27], v[58:59], v[34:35], v[24:27] cbsz:4 abid:8
    s_waitcnt lgkmcnt(3)
    s_add_u32 m0, s48, 17408
    v_xor_b32 v3, 0x11020, v1
    buffer_load_dwordx4 v3, s[4:7], s47 offen nt lds
    v_mfma_f32_4x4x4_16b_bf16 v[12:15], v[58:59], v[36:37], v[12:15] cbsz:4 abid:12
    s_waitcnt lgkmcnt(2)
    v_mfma_f32_4x4x4_16b_bf16 v[16:19], v[58:59], v[38:39], v[16:19] cbsz:4 abid:12
    s_waitcnt lgkmcnt(1)
    v_mfma_f32_4x4x4_16b_bf16 v[20:23], v[58:59], v[40:41], v[20:23] cbsz:4 abid:12
    s_waitcnt lgkmcnt(0)
    v_mfma_f32_4x4x4_16b_bf16 v[24:27], v[58:59], v[42:43], v[24:27] cbsz:4 abid:12
    v_mfma_f32_4x4x4_16b_bf16 v[12:15], v[44:45], v[64:65], v[12:15] cbsz:4 abid:0
    v_mfma_f32_4x4x4_16b_bf16 v[16:19], v[44:45], v[66:67], v[16:19] cbsz:4 abid:0
    v_mfma_f32_4x4x4_16b_bf16 v[20:23], v[44:45], v[68:69], v[20:23] cbsz:4 abid:0
    v_mfma_f32_4x4x4_16b_bf16 v[24:27], v[44:45], v[70:71], v[24:27] cbsz:4 abid:0
    v_mfma_f32_4x4x4_16b_bf16 v[12:15], v[44:45], v[72:73], v[12:15] cbsz:4 abid:4
    v_mfma_f32_4x4x4_16b_bf16 v[16:19], v[44:45], v[74:75], v[16:19] cbsz:4 abid:4
    v_mfma_f32_4x4x4_16b_bf16 v[20:23], v[44:45], v[76:77], v[20:23] cbsz:4 abid:4
    v_mfma_f32_4x4x4_16b_bf16 v[24:27], v[44:45], v[78:79], v[24:27] cbsz:4 abid:4
    v_mfma_f32_4x4x4_16b_bf16 v[12:15], v[44:45], v[80:81], v[12:15] cbsz:4 abid:8
    v_mfma_f32_4x4x4_16b_bf16 v[16:19], v[44:45], v[82:83], v[16:19] cbsz:4 abid:8
    v_mfma_f32_4x4x4_16b_bf16 v[20:23], v[44:45], v[84:85], v[20:23] cbsz:4 abid:8
    v_mfma_f32_4x4x4_16b_bf16 v[24:27], v[44:45], v[86:87], v[24:27] cbsz:4 abid:8
    v_mfma_f32_4x4x4_16b_bf16 v[12:15], v[44:45], v[88:89], v[12:15] cbsz:4 abid:12
    v_mfma_f32_4x4x4_16b_bf16 v[16:19], v[44:45], v[90:91], v[16:19] cbsz:4 abid:12
    s_add_u32 m0, s48, 18432
    v_xor_b32 v3, 0x12040, v1
    buffer_load_dwordx4 v3, s[4:7], s47 offen nt lds
    v_mfma_f32_4x4x4_16b_bf16 v[20:23], v[44:45], v[92:93], v[20:23] cbsz:4 abid:12
    v_mfma_f32_4x4x4_16b_bf16 v[24:27], v[44:45], v[94:95], v[24:27] cbsz:4 abid:12
    v_mfma_f32_4x4x4_16b_bf16 v[12:15], v[46:47], v[96:97], v[12:15] cbsz:4 abid:0
    v_mfma_f32_4x4x4_16b_bf16 v[16:19], v[46:47], v[98:99], v[16:19] cbsz:4 abid:0
    v_mfma_f32_4x4x4_16b_bf16 v[20:23], v[46:47], v[100:101], v[20:23] cbsz:4 abid:0
    v_mfma_f32_4x4x4_16b_bf16 v[24:27], v[46:47], v[102:103], v[24:27] cbsz:4 abid:0
    v_mfma_f32_4x4x4_16b_bf16 v[12:15], v[46:47], v[104:105], v[12:15] cbsz:4 abid:4
    v_mfma_f32_4x4x4_16b_bf16 v[16:19], v[46:47], v[106:107], v[16:19] cbsz:4 abid:4
    v_mfma_f32_4x4x4_16b_bf16 v[20:23], v[46:47], v[108:109], v[20:23] cbsz:4 abid:4
    v_mfma_f32_4x4x4_16b_bf16 v[24:27], v[46:47], v[110:111], v[24:27] cbsz:4 abid:4
    v_mfma_f32_4x4x4_16b_bf16 v[12:15], v[46:47], v[112:113], v[12:15] cbsz:4 abid:8
    v_mfma_f32_4x4x4_16b_bf16 v[16:19], v[46:47], v[114:115], v[16:19] cbsz:4 abid:8
    v_mfma_f32_4x4x4_16b_bf16 v[20:23], v[46:47], v[116:117], v[20:23] cbsz:4 abid:8
    v_mfma_f32_4x4x4_16b_bf16 v[24:27], v[46:47], v[118:119], v[24:27] cbsz:4 abid:8
    v_mfma_f32_4x4x4_16b_bf16 v[12:15], v[46:47], v[120:121], v[12:15] cbsz:4 abid:12
    v_mfma_f32_4x4x4_16b_bf16 v[16:19], v[46:47], v[122:123], v[16:19] cbsz:4 abid:12
    v_mfma_f32_4x4x4_16b_bf16 v[20:23], v[46:47], v[124:125], v[20:23] cbsz:4 abid:12
    v_mfma_f32_4x4x4_16b_bf16 v[24:27], v[46:47], v[126:127], v[24:27] cbsz:4 abid:12
    v_mfma_f32_4x4x4_16b_bf16 v[12:15], v[48:49], v[128:129], v[12:15] cbsz:4 abid:0
    s_add_u32 m0, s48, 19456
    v_xor_b32 v3, 0x13060, v1
    buffer_load_dwordx4 v3, s[4:7], s47 offen nt lds
    v_mfma_f32_4x4x4_16b_bf16 v[16:19], v[48:49], v[130:131], v[16:19] cbsz:4 abid:0
    v_mfma_f32_4x4x4_16b_bf16 v[20:23], v[48:49], v[132:133], v[20:23] cbsz:4 abid:0
    v_mfma_f32_4x4x4_16b_bf16 v[24:27], v[48:49], v[134:135], v[24:27] cbsz:4 abid:0
    v_mfma_f32_4x4x4_16b_bf16 v[12:15], v[48:49], v[136:137], v[12:15] cbsz:4 abid:4
    v_mfma_f32_4x4x4_16b_bf16 v[16:19], v[48:49], v[138:139], v[16:19] cbsz:4 abid:4
    v_mfma_f32_4x4x4_16b_bf16 v[20:23], v[48:49], v[140:141], v[20:23] cbsz:4 abid:4
    v_mfma_f32_4x4x4_16b_bf16 v[24:27], v[48:49], v[142:143], v[24:27] cbsz:4 abid:4
    v_mfma_f32_4x4x4_16b_bf16 v[12:15], v[48:49], v[144:145], v[12:15] cbsz:4 abid:8
    v_mfma_f32_4x4x4_16b_bf16 v[16:19], v[48:49], v[146:147], v[16:19] cbsz:4 abid:8
    v_mfma_f32_4x4x4_16b_bf16 v[20:23], v[48:49], v[148:149], v[20:23] cbsz:4 abid:8
    v_mfma_f32_4x4x4_16b_bf16 v[24:27], v[48:49], v[150:151], v[24:27] cbsz:4 abid:8
    v_mfma_f32_4x4x4_16b_bf16 v[12:15], v[48:49], v[152:153], v[12:15] cbsz:4 abid:12
    v_mfma_f32_4x4x4_16b_bf16 v[16:19], v[48:49], v[154:155], v[16:19] cbsz:4 abid:12
    v_mfma_f32_4x4x4_16b_bf16 v[20:23], v[48:49], v[156:157], v[20:23] cbsz:4 abid:12
    v_mfma_f32_4x4x4_16b_bf16 v[24:27], v[48:49], v[158:159], v[24:27] cbsz:4 abid:12
    v_mfma_f32_4x4x4_16b_bf16 v[12:15], v[50:51], v[160:161], v[12:15] cbsz:4 abid:0
    v_mfma_f32_4x4x4_16b_bf16 v[16:19], v[50:51], v[162:163], v[16:19] cbsz:4 abid:0
    v_mfma_f32_4x4x4_16b_bf16 v[20:23], v[50:51], v[164:165], v[20:23] cbsz:4 abid:0
    v_mfma_f32_4x4x4_16b_bf16 v[24:27], v[50:51], v[166:167], v[24:27] cbsz:4 abid:0
    s_add_u32 m0, s48, 20480
    v_xor_b32 v3, 0x14080, v1
    buffer_load_dwordx4 v3, s[4:7], s47 offen nt lds
    v_mfma_f32_4x4x4_16b_bf16 v[12:15], v[50:51], v[168:169], v[12:15] cbsz:4 abid:4
    v_mfma_f32_4x4x4_16b_bf16 v[16:19], v[50:51], v[170:171], v[16:19] cbsz:4 abid:4
    v_mfma_f32_4x4x4_16b_bf16 v[20:23], v[50:51], v[172:173], v[20:23] cbsz:4 abid:4
    v_mfma_f32_4x4x4_16b_bf16 v[24:27], v[50:51], v[174:175], v[24:27] cbsz:4 abid:4
    v_mfma_f32_4x4x4_16b_bf16 v[12:15], v[50:51], v[176:177], v[12:15] cbsz:4 abid:8
    v_mfma_f32_4x4x4_16b_bf16 v[16:19], v[50:51], v[178:179], v[16:19] cbsz:4 abid:8
    v_mfma_f32_4x4x4_16b_bf16 v[20:23], v[50:51], v[180:181], v[20:23] cbsz:4 abid:8
    v_mfma_f32_4x4x4_16b_bf16 v[24:27], v[50:51], v[182:183], v[24:27] cbsz:4 abid:8
    v_mfma_f32_4x4x4_16b_bf16 v[12:15], v[50:51], v[184:185], v[12:15] cbsz:4 abid:12
    v_mfma_f32_4x4x4_16b_bf16 v[16:19], v[50:51], v[186:187], v[16:19] cbsz:4 abid:12
    v_mfma_f32_4x4x4_16b_bf16 v[20:23], v[50:51], v[188:189], v[20:23] cbsz:4 abid:12
    v_mfma_f32_4x4x4_16b_bf16 v[24:27], v[50:51], v[190:191], v[24:27] cbsz:4 abid:12
    v_mfma_f32_4x4x4_16b_bf16 v[12:15], v[52:53], v[192:193], v[12:15] cbsz:4 abid:0
    v_mfma_f32_4x4x4_16b_bf16 v[16:19], v[52:53], v[194:195], v[16:19] cbsz:4 abid:0
    v_mfma_f32_4x4x4_16b_bf16 v[20:23], v[52:53], v[196:197], v[20:23] cbsz:4 abid:0
    v_mfma_f32_4x4x4_16b_bf16 v[24:27], v[52:53], v[198:199], v[24:27] cbsz:4 abid:0
    v_mfma_f32_4x4x4_16b_bf16 v[12:15], v[52:53], v[200:201], v[12:15] cbsz:4 abid:4
    v_mfma_f32_4x4x4_16b_bf16 v[16:19], v[52:53], v[202:203], v[16:19] cbsz:4 abid:4
    v_mfma_f32_4x4x4_16b_bf16 v[20:23], v[52:53], v[204:205], v[20:23] cbsz:4 abid:4
    s_add_u32 m0, s48, 21504
    v_xor_b32 v3, 0x150a0, v1
    buffer_load_dwordx4 v3, s[4:7], s47 offen nt lds
    v_mfma_f32_4x4x4_16b_bf16 v[24:27], v[52:53], v[206:207], v[24:27] cbsz:4 abid:4
    v_mfma_f32_4x4x4_16b_bf16 v[12:15], v[52:53], v[208:209], v[12:15] cbsz:4 abid:8
    v_mfma_f32_4x4x4_16b_bf16 v[16:19], v[52:53], v[210:211], v[16:19] cbsz:4 abid:8
    v_mfma_f32_4x4x4_16b_bf16 v[20:23], v[52:53], v[212:213], v[20:23] cbsz:4 abid:8
    v_mfma_f32_4x4x4_16b_bf16 v[24:27], v[52:53], v[214:215], v[24:27] cbsz:4 abid:8
    v_mfma_f32_4x4x4_16b_bf16 v[12:15], v[52:53], v[216:217], v[12:15] cbsz:4 abid:12
    v_mfma_f32_4x4x4_16b_bf16 v[16:19], v[52:53], v[218:219], v[16:19] cbsz:4 abid:12
    v_mfma_f32_4x4x4_16b_bf16 v[20:23], v[52:53], v[220:221], v[20:23] cbsz:4 abid:12
    v_mfma_f32_4x4x4_16b_bf16 v[24:27], v[52:53], v[222:223], v[24:27] cbsz:4 abid:12
    v_mfma_f32_4x4x4_16b_bf16 v[12:15], v[54:55], v[224:225], v[12:15] cbsz:4 abid:0
    v_mfma_f32_4x4x4_16b_bf16 v[16:19], v[54:55], v[226:227], v[16:19] cbsz:4 abid:0
    v_mfma_f32_4x4x4_16b_bf16 v[20:23], v[54:55], v[228:229], v[20:23] cbsz:4 abid:0
    v_mfma_f32_4x4x4_16b_bf16 v[24:27], v[54:55], v[230:231], v[24:27] cbsz:4 abid:0
    v_mfma_f32_4x4x4_16b_bf16 v[12:15], v[54:55], v[232:233], v[12:15] cbsz:4 abid:4
    v_mfma_f32_4x4x4_16b_bf16 v[16:19], v[54:55], v[234:235], v[16:19] cbsz:4 abid:4
    v_mfma_f32_4x4x4_16b_bf16 v[20:23], v[54:55], v[236:237], v[20:23] cbsz:4 abid:4
    v_mfma_f32_4x4x4_16b_bf16 v[24:27], v[54:55], v[238:239], v[24:27] cbsz:4 abid:4
    v_mfma_f32_4x4x4_16b_bf16 v[12:15], v[54:55], v[240:241], v[12:15] cbsz:4 abid:8
    v_mfma_f32_4x4x4_16b_bf16 v[16:19], v[54:55], v[242:243], v[16:19] cbsz:4 abid:8
    s_add_u32 m0, s48, 22528
    v_xor_b32 v3, 0x160c0, v1
    buffer_load_dwordx4 v3, s[4:7], s47 offen nt lds
    v_mfma_f32_4x4x4_16b_bf16 v[20:23], v[54:55], v[244:245], v[20:23] cbsz:4 abid:8
    v_mfma_f32_4x4x4_16b_bf16 v[24:27], v[54:55], v[246:247], v[24:27] cbsz:4 abid:8
    v_mfma_f32_4x4x4_16b_bf16 v[12:15], v[54:55], v[248:249], v[12:15] cbsz:4 abid:12
    v_mfma_f32_4x4x4_16b_bf16 v[16:19], v[54:55], v[250:251], v[16:19] cbsz:4 abid:12
    v_mfma_f32_4x4x4_16b_bf16 v[20:23], v[54:55], v[252:253], v[20:23] cbsz:4 abid:12
    v_mfma_f32_4x4x4_16b_bf16 v[24:27], v[54:55], v[254:255], v[24:27] cbsz:4 abid:12
    s_add_u32 m0, s48, 23552
    v_xor_b32 v3, 0x170e0, v1
    buffer_load_dwordx4 v3, s[4:7], s47 offen nt lds
    s_add_u32 m0, s48, 24576
    v_xor_b32 v3, 0x18000, v1
    buffer_load_dwordx4 v3, s[4:7], s47 offen nt lds
    s_add_u32 m0, s48, 25600
    v_xor_b32 v3, 0x19020, v1
    buffer_load_dwordx4 v3, s[4:7], s47 offen nt lds
    s_mov_b32 s71, 26
    s_branch L_p1_44
L_p1_43:
    ds_read_b128 v[44:47], v9 offset:13312
    ds_read_b128 v[48:51], v9 offset:13376
    ds_read_b128 v[52:55], v9 offset:13440
    ds_read_b128 v[56:59], v9 offset:13504
    s_waitcnt lgkmcnt(3)
    v_mfma_f32_16x16x32_bf16 v[12:15], a[0:3], v[44:47], 0
    v_mfma_f32_16x16x32_bf16 v[16:19], a[32:35], v[44:47], 0
    v_mfma_f32_16x16x32_bf16 v[20:23], a[64:67], v[44:47], 0
    v_mfma_f32_16x16x32_bf16 v[24:27], a[96:99], v[44:47], 0
    v_mfma_f32_16x16x32_bf16 v[28:31], a[128:131], v[44:47], 0
    v_mfma_f32_16x16x32_bf16 v[32:35], a[160:163], v[44:47], 0
    v_mfma_f32_16x16x32_bf16 v[36:39], a[192:195], v[44:47], 0
    v_mfma_f32_16x16x32_bf16 v[40:43], a[224:227], v[44:47], 0
    ds_read_b128 v[44:47], v9 offset:13568
    s_waitcnt lgkmcnt(3)
    v_mfma_f32_16x16x32_bf16 v[12:15], a[4:7], v[48:51], v[12:15]
    v_mfma_f32_16x16x32_bf16 v[16:19], a[36:39], v[48:51], v[16:19]
    v_mfma_f32_16x16x32_bf16 v[20:23], a[68:71], v[48:51], v[20:23]
    v_mfma_f32_16x16x32_bf16 v[24:27], a[100:103], v[48:51], v[24:27]
    v_mfma_f32_16x16x32_bf16 v[28:31], a[132:135], v[48:51], v[28:31]
    v_mfma_f32_16x16x32_bf16 v[32:35], a[164:167], v[48:51], v[32:35]
    v_mfma_f32_16x16x32_bf16 v[36:39], a[196:199], v[48:51], v[36:39]
    v_mfma_f32_16x16x32_bf16 v[40:43], a[228:231], v[48:51], v[40:43]
    ds_read_b128 v[48:51], v9 offset:13632
    s_waitcnt lgkmcnt(3)
    v_mfma_f32_16x16x32_bf16 v[12:15], a[8:11], v[52:55], v[12:15]
    v_mfma_f32_16x16x32_bf16 v[16:19], a[40:43], v[52:55], v[16:19]
    v_mfma_f32_16x16x32_bf16 v[20:23], a[72:75], v[52:55], v[20:23]
    v_mfma_f32_16x16x32_bf16 v[24:27], a[104:107], v[52:55], v[24:27]
    v_mfma_f32_16x16x32_bf16 v[28:31], a[136:139], v[52:55], v[28:31]
    v_mfma_f32_16x16x32_bf16 v[32:35], a[168:171], v[52:55], v[32:35]
    v_mfma_f32_16x16x32_bf16 v[36:39], a[200:203], v[52:55], v[36:39]
    v_mfma_f32_16x16x32_bf16 v[40:43], a[232:235], v[52:55], v[40:43]
    ds_read_b128 v[52:55], v9 offset:13696
    s_waitcnt lgkmcnt(3)
    v_mfma_f32_16x16x32_bf16 v[12:15], a[12:15], v[56:59], v[12:15]
    v_mfma_f32_16x16x32_bf16 v[16:19], a[44:47], v[56:59], v[16:19]
    v_mfma_f32_16x16x32_bf16 v[20:23], a[76:79], v[56:59], v[20:23]
    v_mfma_f32_16x16x32_bf16 v[24:27], a[108:111], v[56:59], v[24:27]
    v_mfma_f32_16x16x32_bf16 v[28:31], a[140:143], v[56:59], v[28:31]
    v_mfma_f32_16x16x32_bf16 v[32:35], a[172:175], v[56:59], v[32:35]
    v_mfma_f32_16x16x32_bf16 v[36:39], a[204:207], v[56:59], v[36:39]
    v_mfma_f32_16x16x32_bf16 v[40:43], a[236:239], v[56:59], v[40:43]
    ds_read_b128 v[56:59], v9 offset:13760
    s_waitcnt lgkmcnt(3)
    v_mfma_f32_16x16x32_bf16 v[12:15], a[16:19], v[44:47], v[12:15]
    v_mfma_f32_16x16x32_bf16 v[16:19], a[48:51], v[44:47], v[16:19]
    v_mfma_f32_16x16x32_bf16 v[20:23], a[80:83], v[44:47], v[20:23]
    v_mfma_f32_16x16x32_bf16 v[24:27], a[112:115], v[44:47], v[24:27]
    v_mfma_f32_16x16x32_bf16 v[28:31], a[144:147], v[44:47], v[28:31]
    v_mfma_f32_16x16x32_bf16 v[32:35], a[176:179], v[44:47], v[32:35]
    v_mfma_f32_16x16x32_bf16 v[36:39], a[208:211], v[44:47], v[36:39]
    v_mfma_f32_16x16x32_bf16 v[40:43], a[240:243], v[44:47], v[40:43]
    s_waitcnt lgkmcnt(2)
    v_mfma_f32_16x16x32_bf16 v[12:15], a[20:23], v[48:51], v[12:15]
    v_mfma_f32_16x16x32_bf16 v[16:19], a[52:55], v[48:51], v[16:19]
    v_mfma_f32_16x16x32_bf16 v[20:23], a[84:87], v[48:51], v[20:23]
    v_mfma_f32_16x16x32_bf16 v[24:27], a[116:119], v[48:51], v[24:27]
    v_mfma_f32_16x16x32_bf16 v[28:31], a[148:151], v[48:51], v[28:31]
    v_mfma_f32_16x16x32_bf16 v[32:35], a[180:183], v[48:51], v[32:35]
    v_mfma_f32_16x16x32_bf16 v[36:39], a[212:215], v[48:51], v[36:39]
    v_mfma_f32_16x16x32_bf16 v[40:43], a[244:247], v[48:51], v[40:43]
    s_waitcnt lgkmcnt(1)
    v_mfma_f32_16x16x32_bf16 v[12:15], a[24:27], v[52:55], v[12:15]
    v_mfma_f32_16x16x32_bf16 v[16:19], a[56:59], v[52:55], v[16:19]
    v_mfma_f32_16x16x32_bf16 v[20:23], a[88:91], v[52:55], v[20:23]
    v_mfma_f32_16x16x32_bf16 v[24:27], a[120:123], v[52:55], v[24:27]
    v_mfma_f32_16x16x32_bf16 v[28:31], a[152:155], v[52:55], v[28:31]
    v_mfma_f32_16x16x32_bf16 v[32:35], a[184:187], v[52:55], v[32:35]
    v_mfma_f32_16x16x32_bf16 v[36:39], a[216:219], v[52:55], v[36:39]
    v_mfma_f32_16x16x32_bf16 v[40:43], a[248:251], v[52:55], v[40:43]
    s_waitcnt lgkmcnt(0)
    v_mfma_f32_16x16x32_bf16 v[12:15], a[28:31], v[56:59], v[12:15]
    v_mfma_f32_16x16x32_bf16 v[16:19], a[60:63], v[56:59], v[16:19]
    v_mfma_f32_16x16x32_bf16 v[20:23], a[92:95], v[56:59], v[20:23]
    v_mfma_f32_16x16x32_bf16 v[24:27], a[124:127], v[56:59], v[24:27]
    v_mfma_f32_16x16x32_bf16 v[28:31], a[156:159], v[56:59], v[28:31]
    v_mfma_f32_16x16x32_bf16 v[32:35], a[188:191], v[56:59], v[32:35]
    v_mfma_f32_16x16x32_bf16 v[36:39], a[220:223], v[56:59], v[36:39]
    v_mfma_f32_16x16x32_bf16 v[40:43], a[252:255], v[56:59], v[40:43]
    s_nop 0
    v_max3_f32 v10, v12, v13, v14
    v_max3_f32 v11, v15, v16, v17
    v_max3_f32 v10, v10, v18, v19
    v_max3_f32 v11, v11, v20, v21
    v_max3_f32 v10, v10, v22, v23
    v_max3_f32 v11, v11, v24, v25
    v_max3_f32 v10, v10, v26, v27
    v_max3_f32 v11, v11, v28, v29
    v_max3_f32 v10, v10, v30, v31
    v_max3_f32 v11, v11, v32, v33
    v_max3_f32 v10, v10, v34, v35
    v_max3_f32 v11, v11, v36, v37
    v_max3_f32 v10, v10, v38, v39
    v_max3_f32 v11, v11, v40, v41
    v_max3_f32 v10, v10, v42, v43
    v_max_f32 v10, v10, v11
    v_mov_b32 v11, v10
    s_nop 1
    v_permlane16_swap_b32 v10, v11
    v_max_f32 v10, v10, v11
    v_mov_b32 v11, v10
    s_nop 1
    v_permlane32_swap_b32 v10, v11
    v_max_f32 v10, v10, v11
    v_mul_f32 v10, s58, v10
    v_mov_b32 v60, s58
    v_pk_fma_f32 v[12:13], v[12:13], v[60:61], v[10:11] op_sel_hi:[1,0,0] neg_lo:[0,0,1] neg_hi:[0,0,1]
    v_pk_fma_f32 v[14:15], v[14:15], v[60:61], v[10:11] op_sel_hi:[1,0,0] neg_lo:[0,0,1] neg_hi:[0,0,1]
    v_pk_fma_f32 v[16:17], v[16:17], v[60:61], v[10:11] op_sel_hi:[1,0,0] neg_lo:[0,0,1] neg_hi:[0,0,1]
    v_pk_fma_f32 v[18:19], v[18:19], v[60:61], v[10:11] op_sel_hi:[1,0,0] neg_lo:[0,0,1] neg_hi:[0,0,1]
    v_pk_fma_f32 v[20:21], v[20:21], v[60:61], v[10:11] op_sel_hi:[1,0,0] neg_lo:[0,0,1] neg_hi:[0,0,1]
    v_pk_fma_f32 v[22:23], v[22:23], v[60:61], v[10:11] op_sel_hi:[1,0,0] neg_lo:[0,0,1] neg_hi:[0,0,1]
    v_pk_fma_f32 v[24:25], v[24:25], v[60:61], v[10:11] op_sel_hi:[1,0,0] neg_lo:[0,0,1] neg_hi:[0,0,1]
    v_pk_fma_f32 v[26:27], v[26:27], v[60:61], v[10:11] op_sel_hi:[1,0,0] neg_lo:[0,0,1] neg_hi:[0,0,1]
    v_pk_fma_f32 v[28:29], v[28:29], v[60:61], v[10:11] op_sel_hi:[1,0,0] neg_lo:[0,0,1] neg_hi:[0,0,1]
    v_pk_fma_f32 v[30:31], v[30:31], v[60:61], v[10:11] op_sel_hi:[1,0,0] neg_lo:[0,0,1] neg_hi:[0,0,1]
    v_pk_fma_f32 v[32:33], v[32:33], v[60:61], v[10:11] op_sel_hi:[1,0,0] neg_lo:[0,0,1] neg_hi:[0,0,1]
    v_pk_fma_f32 v[34:35], v[34:35], v[60:61], v[10:11] op_sel_hi:[1,0,0] neg_lo:[0,0,1] neg_hi:[0,0,1]
    v_pk_fma_f32 v[36:37], v[36:37], v[60:61], v[10:11] op_sel_hi:[1,0,0] neg_lo:[0,0,1] neg_hi:[0,0,1]
    v_pk_fma_f32 v[38:39], v[38:39], v[60:61], v[10:11] op_sel_hi:[1,0,0] neg_lo:[0,0,1] neg_hi:[0,0,1]
    v_pk_fma_f32 v[40:41], v[40:41], v[60:61], v[10:11] op_sel_hi:[1,0,0] neg_lo:[0,0,1] neg_hi:[0,0,1]
    v_pk_fma_f32 v[42:43], v[42:43], v[60:61], v[10:11] op_sel_hi:[1,0,0] neg_lo:[0,0,1] neg_hi:[0,0,1]
    v_exp_f32 v12, v12
    v_exp_f32 v13, v13
    v_exp_f32 v14, v14
    v_exp_f32 v15, v15
    v_exp_f32 v16, v16
    v_exp_f32 v17, v17
    v_exp_f32 v18, v18
    v_exp_f32 v19, v19
    v_exp_f32 v20, v20
    v_exp_f32 v21, v21
    v_exp_f32 v22, v22
    v_exp_f32 v23, v23
    v_exp_f32 v24, v24
    v_exp_f32 v25, v25
    v_exp_f32 v26, v26
    v_exp_f32 v27, v27
    v_exp_f32 v28, v28
    v_exp_f32 v29, v29
    v_exp_f32 v30, v30
    v_exp_f32 v31, v31
    v_exp_f32 v32, v32
    v_exp_f32 v33, v33
    v_exp_f32 v34, v34
    v_exp_f32 v35, v35
    v_exp_f32 v36, v36
    v_exp_f32 v37, v37
    v_exp_f32 v38, v38
    v_exp_f32 v39, v39
    v_exp_f32 v40, v40
    v_exp_f32 v41, v41
    v_exp_f32 v42, v42
    v_exp_f32 v43, v43
    v_cvt_pk_bf16_f32 v44, v12, v13
    v_cvt_pk_bf16_f32 v45, v14, v15
    v_cvt_pk_bf16_f32 v46, v16, v17
    v_cvt_pk_bf16_f32 v47, v18, v19
    v_cvt_pk_bf16_f32 v48, v20, v21
    v_cvt_pk_bf16_f32 v49, v22, v23
    v_cvt_pk_bf16_f32 v50, v24, v25
    v_cvt_pk_bf16_f32 v51, v26, v27
    v_cvt_pk_bf16_f32 v52, v28, v29
    v_cvt_pk_bf16_f32 v53, v30, v31
    v_cvt_pk_bf16_f32 v54, v32, v33
    v_cvt_pk_bf16_f32 v55, v34, v35
    v_cvt_pk_bf16_f32 v56, v36, v37
    v_cvt_pk_bf16_f32 v57, v38, v39
    v_cvt_pk_bf16_f32 v58, v40, v41
    v_cvt_pk_bf16_f32 v59, v42, v43
    v_pk_add_f32 v[12:13], v[12:13], v[28:29]
    v_pk_add_f32 v[14:15], v[14:15], v[30:31]
    v_pk_add_f32 v[16:17], v[16:17], v[32:33]
    v_pk_add_f32 v[18:19], v[18:19], v[34:35]
    v_pk_add_f32 v[20:21], v[20:21], v[36:37]
    v_pk_add_f32 v[22:23], v[22:23], v[38:39]
    v_pk_add_f32 v[24:25], v[24:25], v[40:41]
    v_pk_add_f32 v[26:27], v[26:27], v[42:43]
    v_pk_add_f32 v[12:13], v[12:13], v[20:21]
    v_pk_add_f32 v[14:15], v[14:15], v[22:23]
    v_pk_add_f32 v[16:17], v[16:17], v[24:25]
    v_pk_add_f32 v[18:19], v[18:19], v[26:27]
    v_pk_add_f32 v[12:13], v[12:13], v[16:17]
    v_pk_add_f32 v[14:15], v[14:15], v[18:19]
    v_pk_add_f32 v[12:13], v[12:13], v[14:15]
    v_add_f32 v11, v12, v13
    v_mov_b32 v12, v11
    s_nop 1
    v_permlane16_swap_b32 v11, v12
    v_add_f32 v11, v11, v12
    v_mov_b32 v12, v11
    s_nop 1
    v_permlane32_swap_b32 v11, v12
    v_add_f32 v11, v11, v12
    v_xor_b32 v6, 128, v5
    v_xor_b32 v7, 0x240, v5
    v_xor_b32 v8, 0x2c0, v5
    ds_read_b64_tr_b16 v[28:29], v5 offset:16384
    ds_read_b64_tr_b16 v[30:31], v6 offset:16384
    ds_read_b64_tr_b16 v[32:33], v5 offset:16640
    ds_read_b64_tr_b16 v[34:35], v6 offset:16640
    ds_read_b64_tr_b16 v[36:37], v5 offset:18688
    ds_read_b64_tr_b16 v[38:39], v6 offset:18688
    ds_read_b64_tr_b16 v[40:41], v5 offset:18432
    ds_read_b64_tr_b16 v[42:43], v6 offset:18432
    s_waitcnt lgkmcnt(7)
    v_mfma_f32_4x4x4_16b_bf16 v[12:15], v[56:57], v[28:29], 0 cbsz:4 abid:0
    ds_read_b64_tr_b16 v[28:29], v7 offset:20480
    s_waitcnt lgkmcnt(7)
    v_mfma_f32_4x4x4_16b_bf16 v[16:19], v[56:57], v[30:31], 0 cbsz:4 abid:0
    ds_read_b64_tr_b16 v[30:31], v8 offset:20480
    s_waitcnt lgkmcnt(7)
    v_mfma_f32_4x4x4_16b_bf16 v[20:23], v[56:57], v[32:33], 0 cbsz:4 abid:0
    ds_read_b64_tr_b16 v[32:33], v7 offset:20736
    s_waitcnt lgkmcnt(7)
    v_mfma_f32_4x4x4_16b_bf16 v[24:27], v[56:57], v[34:35], 0 cbsz:4 abid:0
    ds_read_b64_tr_b16 v[34:35], v8 offset:20736
    s_waitcnt lgkmcnt(7)
    v_mfma_f32_4x4x4_16b_bf16 v[12:15], v[56:57], v[36:37], v[12:15] cbsz:4 abid:4
    ds_read_b64_tr_b16 v[36:37], v7 offset:22784
    s_waitcnt lgkmcnt(7)
    v_mfma_f32_4x4x4_16b_bf16 v[16:19], v[56:57], v[38:39], v[16:19] cbsz:4 abid:4
    ds_read_b64_tr_b16 v[38:39], v8 offset:22784
    s_waitcnt lgkmcnt(7)
    v_mfma_f32_4x4x4_16b_bf16 v[20:23], v[56:57], v[40:41], v[20:23] cbsz:4 abid:4
    ds_read_b64_tr_b16 v[40:41], v7 offset:22528
    s_waitcnt lgkmcnt(7)
    v_mfma_f32_4x4x4_16b_bf16 v[24:27], v[56:57], v[42:43], v[24:27] cbsz:4 abid:4
    ds_read_b64_tr_b16 v[42:43], v8 offset:22528
    s_waitcnt lgkmcnt(7)
    v_mfma_f32_4x4x4_16b_bf16 v[12:15], v[56:57], v[28:29], v[12:15] cbsz:4 abid:8
    s_waitcnt lgkmcnt(6)
    v_mfma_f32_4x4x4_16b_bf16 v[16:19], v[56:57], v[30:31], v[16:19] cbsz:4 abid:8
    s_waitcnt lgkmcnt(5)
    v_mfma_f32_4x4x4_16b_bf16 v[20:23], v[56:57], v[32:33], v[20:23] cbsz:4 abid:8
    s_waitcnt lgkmcnt(4)
    v_mfma_f32_4x4x4_16b_bf16 v[24:27], v[56:57], v[34:35], v[24:27] cbsz:4 abid:8
    s_waitcnt lgkmcnt(3)
    v_mfma_f32_4x4x4_16b_bf16 v[12:15], v[56:57], v[36:37], v[12:15] cbsz:4 abid:12
    s_waitcnt lgkmcnt(2)
    v_mfma_f32_4x4x4_16b_bf16 v[16:19], v[56:57], v[38:39], v[16:19] cbsz:4 abid:12
    s_waitcnt lgkmcnt(1)
    v_mfma_f32_4x4x4_16b_bf16 v[20:23], v[56:57], v[40:41], v[20:23] cbsz:4 abid:12
    s_waitcnt lgkmcnt(0)
    v_mfma_f32_4x4x4_16b_bf16 v[24:27], v[56:57], v[42:43], v[24:27] cbsz:4 abid:12
    v_xor_b32 v6, 128, v5
    v_xor_b32 v7, 0x240, v5
    v_xor_b32 v8, 0x2c0, v5
    ds_read_b64_tr_b16 v[28:29], v5 offset:24576
    ds_read_b64_tr_b16 v[30:31], v6 offset:24576
    ds_read_b64_tr_b16 v[32:33], v5 offset:24832
    ds_read_b64_tr_b16 v[34:35], v6 offset:24832
    ds_read_b64_tr_b16 v[36:37], v5 offset:26880
    ds_read_b64_tr_b16 v[38:39], v6 offset:26880
    ds_read_b64_tr_b16 v[40:41], v5 offset:26624
    ds_read_b64_tr_b16 v[42:43], v6 offset:26624
    s_waitcnt lgkmcnt(7)
    v_mfma_f32_4x4x4_16b_bf16 v[12:15], v[58:59], v[28:29], v[12:15] cbsz:4 abid:0
    ds_read_b64_tr_b16 v[28:29], v7 offset:28672
    s_waitcnt lgkmcnt(7)
    v_mfma_f32_4x4x4_16b_bf16 v[16:19], v[58:59], v[30:31], v[16:19] cbsz:4 abid:0
    ds_read_b64_tr_b16 v[30:31], v8 offset:28672
    s_waitcnt lgkmcnt(7)
    v_mfma_f32_4x4x4_16b_bf16 v[20:23], v[58:59], v[32:33], v[20:23] cbsz:4 abid:0
    ds_read_b64_tr_b16 v[32:33], v7 offset:28928
    s_waitcnt lgkmcnt(7)
    v_mfma_f32_4x4x4_16b_bf16 v[24:27], v[58:59], v[34:35], v[24:27] cbsz:4 abid:0
    ds_read_b64_tr_b16 v[34:35], v8 offset:28928
    s_waitcnt lgkmcnt(7)
    v_mfma_f32_4x4x4_16b_bf16 v[12:15], v[58:59], v[36:37], v[12:15] cbsz:4 abid:4
    ds_read_b64_tr_b16 v[36:37], v7 offset:30976
    s_waitcnt lgkmcnt(7)
    v_mfma_f32_4x4x4_16b_bf16 v[16:19], v[58:59], v[38:39], v[16:19] cbsz:4 abid:4
    ds_read_b64_tr_b16 v[38:39], v8 offset:30976
    s_waitcnt lgkmcnt(7)
    v_mfma_f32_4x4x4_16b_bf16 v[20:23], v[58:59], v[40:41], v[20:23] cbsz:4 abid:4
    ds_read_b64_tr_b16 v[40:41], v7 offset:30720
    s_waitcnt lgkmcnt(7)
    v_mfma_f32_4x4x4_16b_bf16 v[24:27], v[58:59], v[42:43], v[24:27] cbsz:4 abid:4
    ds_read_b64_tr_b16 v[42:43], v8 offset:30720
    s_waitcnt lgkmcnt(7)
    v_mfma_f32_4x4x4_16b_bf16 v[12:15], v[58:59], v[28:29], v[12:15] cbsz:4 abid:8
    s_waitcnt lgkmcnt(6)
    v_mfma_f32_4x4x4_16b_bf16 v[16:19], v[58:59], v[30:31], v[16:19] cbsz:4 abid:8
    s_waitcnt lgkmcnt(5)
    v_mfma_f32_4x4x4_16b_bf16 v[20:23], v[58:59], v[32:33], v[20:23] cbsz:4 abid:8
    s_waitcnt lgkmcnt(4)
    v_mfma_f32_4x4x4_16b_bf16 v[24:27], v[58:59], v[34:35], v[24:27] cbsz:4 abid:8
    s_waitcnt lgkmcnt(3)
    v_mfma_f32_4x4x4_16b_bf16 v[12:15], v[58:59], v[36:37], v[12:15] cbsz:4 abid:12
    s_waitcnt lgkmcnt(2)
    v_mfma_f32_4x4x4_16b_bf16 v[16:19], v[58:59], v[38:39], v[16:19] cbsz:4 abid:12
    s_waitcnt lgkmcnt(1)
    v_mfma_f32_4x4x4_16b_bf16 v[20:23], v[58:59], v[40:41], v[20:23] cbsz:4 abid:12
    s_waitcnt lgkmcnt(0)
    v_mfma_f32_4x4x4_16b_bf16 v[24:27], v[58:59], v[42:43], v[24:27] cbsz:4 abid:12
    v_mfma_f32_4x4x4_16b_bf16 v[12:15], v[44:45], v[64:65], v[12:15] cbsz:4 abid:0
    v_mfma_f32_4x4x4_16b_bf16 v[16:19], v[44:45], v[66:67], v[16:19] cbsz:4 abid:0
    v_mfma_f32_4x4x4_16b_bf16 v[20:23], v[44:45], v[68:69], v[20:23] cbsz:4 abid:0
    v_mfma_f32_4x4x4_16b_bf16 v[24:27], v[44:45], v[70:71], v[24:27] cbsz:4 abid:0
    v_mfma_f32_4x4x4_16b_bf16 v[12:15], v[44:45], v[72:73], v[12:15] cbsz:4 abid:4
    v_mfma_f32_4x4x4_16b_bf16 v[16:19], v[44:45], v[74:75], v[16:19] cbsz:4 abid:4
    v_mfma_f32_4x4x4_16b_bf16 v[20:23], v[44:45], v[76:77], v[20:23] cbsz:4 abid:4
    v_mfma_f32_4x4x4_16b_bf16 v[24:27], v[44:45], v[78:79], v[24:27] cbsz:4 abid:4
    v_mfma_f32_4x4x4_16b_bf16 v[12:15], v[44:45], v[80:81], v[12:15] cbsz:4 abid:8
    v_mfma_f32_4x4x4_16b_bf16 v[16:19], v[44:45], v[82:83], v[16:19] cbsz:4 abid:8
    v_mfma_f32_4x4x4_16b_bf16 v[20:23], v[44:45], v[84:85], v[20:23] cbsz:4 abid:8
    v_mfma_f32_4x4x4_16b_bf16 v[24:27], v[44:45], v[86:87], v[24:27] cbsz:4 abid:8
    v_mfma_f32_4x4x4_16b_bf16 v[12:15], v[44:45], v[88:89], v[12:15] cbsz:4 abid:12
    v_mfma_f32_4x4x4_16b_bf16 v[16:19], v[44:45], v[90:91], v[16:19] cbsz:4 abid:12
    v_mfma_f32_4x4x4_16b_bf16 v[20:23], v[44:45], v[92:93], v[20:23] cbsz:4 abid:12
    v_mfma_f32_4x4x4_16b_bf16 v[24:27], v[44:45], v[94:95], v[24:27] cbsz:4 abid:12
    v_mfma_f32_4x4x4_16b_bf16 v[12:15], v[46:47], v[96:97], v[12:15] cbsz:4 abid:0
    v_mfma_f32_4x4x4_16b_bf16 v[16:19], v[46:47], v[98:99], v[16:19] cbsz:4 abid:0
    v_mfma_f32_4x4x4_16b_bf16 v[20:23], v[46:47], v[100:101], v[20:23] cbsz:4 abid:0
    v_mfma_f32_4x4x4_16b_bf16 v[24:27], v[46:47], v[102:103], v[24:27] cbsz:4 abid:0
    v_mfma_f32_4x4x4_16b_bf16 v[12:15], v[46:47], v[104:105], v[12:15] cbsz:4 abid:4
    v_mfma_f32_4x4x4_16b_bf16 v[16:19], v[46:47], v[106:107], v[16:19] cbsz:4 abid:4
    v_mfma_f32_4x4x4_16b_bf16 v[20:23], v[46:47], v[108:109], v[20:23] cbsz:4 abid:4
    v_mfma_f32_4x4x4_16b_bf16 v[24:27], v[46:47], v[110:111], v[24:27] cbsz:4 abid:4
    v_mfma_f32_4x4x4_16b_bf16 v[12:15], v[46:47], v[112:113], v[12:15] cbsz:4 abid:8
    v_mfma_f32_4x4x4_16b_bf16 v[16:19], v[46:47], v[114:115], v[16:19] cbsz:4 abid:8
    v_mfma_f32_4x4x4_16b_bf16 v[20:23], v[46:47], v[116:117], v[20:23] cbsz:4 abid:8
    v_mfma_f32_4x4x4_16b_bf16 v[24:27], v[46:47], v[118:119], v[24:27] cbsz:4 abid:8
    v_mfma_f32_4x4x4_16b_bf16 v[12:15], v[46:47], v[120:121], v[12:15] cbsz:4 abid:12
    v_mfma_f32_4x4x4_16b_bf16 v[16:19], v[46:47], v[122:123], v[16:19] cbsz:4 abid:12
    v_mfma_f32_4x4x4_16b_bf16 v[20:23], v[46:47], v[124:125], v[20:23] cbsz:4 abid:12
    v_mfma_f32_4x4x4_16b_bf16 v[24:27], v[46:47], v[126:127], v[24:27] cbsz:4 abid:12
    v_mfma_f32_4x4x4_16b_bf16 v[12:15], v[48:49], v[128:129], v[12:15] cbsz:4 abid:0
    v_mfma_f32_4x4x4_16b_bf16 v[16:19], v[48:49], v[130:131], v[16:19] cbsz:4 abid:0
    v_mfma_f32_4x4x4_16b_bf16 v[20:23], v[48:49], v[132:133], v[20:23] cbsz:4 abid:0
    v_mfma_f32_4x4x4_16b_bf16 v[24:27], v[48:49], v[134:135], v[24:27] cbsz:4 abid:0
    v_mfma_f32_4x4x4_16b_bf16 v[12:15], v[48:49], v[136:137], v[12:15] cbsz:4 abid:4
    v_mfma_f32_4x4x4_16b_bf16 v[16:19], v[48:49], v[138:139], v[16:19] cbsz:4 abid:4
    v_mfma_f32_4x4x4_16b_bf16 v[20:23], v[48:49], v[140:141], v[20:23] cbsz:4 abid:4
    v_mfma_f32_4x4x4_16b_bf16 v[24:27], v[48:49], v[142:143], v[24:27] cbsz:4 abid:4
    v_mfma_f32_4x4x4_16b_bf16 v[12:15], v[48:49], v[144:145], v[12:15] cbsz:4 abid:8
    v_mfma_f32_4x4x4_16b_bf16 v[16:19], v[48:49], v[146:147], v[16:19] cbsz:4 abid:8
    v_mfma_f32_4x4x4_16b_bf16 v[20:23], v[48:49], v[148:149], v[20:23] cbsz:4 abid:8
    v_mfma_f32_4x4x4_16b_bf16 v[24:27], v[48:49], v[150:151], v[24:27] cbsz:4 abid:8
    v_mfma_f32_4x4x4_16b_bf16 v[12:15], v[48:49], v[152:153], v[12:15] cbsz:4 abid:12
    v_mfma_f32_4x4x4_16b_bf16 v[16:19], v[48:49], v[154:155], v[16:19] cbsz:4 abid:12
    v_mfma_f32_4x4x4_16b_bf16 v[20:23], v[48:49], v[156:157], v[20:23] cbsz:4 abid:12
    v_mfma_f32_4x4x4_16b_bf16 v[24:27], v[48:49], v[158:159], v[24:27] cbsz:4 abid:12
    v_mfma_f32_4x4x4_16b_bf16 v[12:15], v[50:51], v[160:161], v[12:15] cbsz:4 abid:0
    v_mfma_f32_4x4x4_16b_bf16 v[16:19], v[50:51], v[162:163], v[16:19] cbsz:4 abid:0
    v_mfma_f32_4x4x4_16b_bf16 v[20:23], v[50:51], v[164:165], v[20:23] cbsz:4 abid:0
    v_mfma_f32_4x4x4_16b_bf16 v[24:27], v[50:51], v[166:167], v[24:27] cbsz:4 abid:0
    v_mfma_f32_4x4x4_16b_bf16 v[12:15], v[50:51], v[168:169], v[12:15] cbsz:4 abid:4
    v_mfma_f32_4x4x4_16b_bf16 v[16:19], v[50:51], v[170:171], v[16:19] cbsz:4 abid:4
    v_mfma_f32_4x4x4_16b_bf16 v[20:23], v[50:51], v[172:173], v[20:23] cbsz:4 abid:4
    v_mfma_f32_4x4x4_16b_bf16 v[24:27], v[50:51], v[174:175], v[24:27] cbsz:4 abid:4
    v_mfma_f32_4x4x4_16b_bf16 v[12:15], v[50:51], v[176:177], v[12:15] cbsz:4 abid:8
    v_mfma_f32_4x4x4_16b_bf16 v[16:19], v[50:51], v[178:179], v[16:19] cbsz:4 abid:8
    v_mfma_f32_4x4x4_16b_bf16 v[20:23], v[50:51], v[180:181], v[20:23] cbsz:4 abid:8
    v_mfma_f32_4x4x4_16b_bf16 v[24:27], v[50:51], v[182:183], v[24:27] cbsz:4 abid:8
    v_mfma_f32_4x4x4_16b_bf16 v[12:15], v[50:51], v[184:185], v[12:15] cbsz:4 abid:12
    v_mfma_f32_4x4x4_16b_bf16 v[16:19], v[50:51], v[186:187], v[16:19] cbsz:4 abid:12
    v_mfma_f32_4x4x4_16b_bf16 v[20:23], v[50:51], v[188:189], v[20:23] cbsz:4 abid:12
    v_mfma_f32_4x4x4_16b_bf16 v[24:27], v[50:51], v[190:191], v[24:27] cbsz:4 abid:12
    v_mfma_f32_4x4x4_16b_bf16 v[12:15], v[52:53], v[192:193], v[12:15] cbsz:4 abid:0
    v_mfma_f32_4x4x4_16b_bf16 v[16:19], v[52:53], v[194:195], v[16:19] cbsz:4 abid:0
    v_mfma_f32_4x4x4_16b_bf16 v[20:23], v[52:53], v[196:197], v[20:23] cbsz:4 abid:0
    v_mfma_f32_4x4x4_16b_bf16 v[24:27], v[52:53], v[198:199], v[24:27] cbsz:4 abid:0
    v_mfma_f32_4x4x4_16b_bf16 v[12:15], v[52:53], v[200:201], v[12:15] cbsz:4 abid:4
    v_mfma_f32_4x4x4_16b_bf16 v[16:19], v[52:53], v[202:203], v[16:19] cbsz:4 abid:4
    v_mfma_f32_4x4x4_16b_bf16 v[20:23], v[52:53], v[204:205], v[20:23] cbsz:4 abid:4
    v_mfma_f32_4x4x4_16b_bf16 v[24:27], v[52:53], v[206:207], v[24:27] cbsz:4 abid:4
    v_mfma_f32_4x4x4_16b_bf16 v[12:15], v[52:53], v[208:209], v[12:15] cbsz:4 abid:8
    v_mfma_f32_4x4x4_16b_bf16 v[16:19], v[52:53], v[210:211], v[16:19] cbsz:4 abid:8
    v_mfma_f32_4x4x4_16b_bf16 v[20:23], v[52:53], v[212:213], v[20:23] cbsz:4 abid:8
    v_mfma_f32_4x4x4_16b_bf16 v[24:27], v[52:53], v[214:215], v[24:27] cbsz:4 abid:8
    v_mfma_f32_4x4x4_16b_bf16 v[12:15], v[52:53], v[216:217], v[12:15] cbsz:4 abid:12
    v_mfma_f32_4x4x4_16b_bf16 v[16:19], v[52:53], v[218:219], v[16:19] cbsz:4 abid:12
    v_mfma_f32_4x4x4_16b_bf16 v[20:23], v[52:53], v[220:221], v[20:23] cbsz:4 abid:12
    v_mfma_f32_4x4x4_16b_bf16 v[24:27], v[52:53], v[222:223], v[24:27] cbsz:4 abid:12
    v_mfma_f32_4x4x4_16b_bf16 v[12:15], v[54:55], v[224:225], v[12:15] cbsz:4 abid:0
    v_mfma_f32_4x4x4_16b_bf16 v[16:19], v[54:55], v[226:227], v[16:19] cbsz:4 abid:0
    v_mfma_f32_4x4x4_16b_bf16 v[20:23], v[54:55], v[228:229], v[20:23] cbsz:4 abid:0
    v_mfma_f32_4x4x4_16b_bf16 v[24:27], v[54:55], v[230:231], v[24:27] cbsz:4 abid:0
    v_mfma_f32_4x4x4_16b_bf16 v[12:15], v[54:55], v[232:233], v[12:15] cbsz:4 abid:4
    v_mfma_f32_4x4x4_16b_bf16 v[16:19], v[54:55], v[234:235], v[16:19] cbsz:4 abid:4
    v_mfma_f32_4x4x4_16b_bf16 v[20:23], v[54:55], v[236:237], v[20:23] cbsz:4 abid:4
    v_mfma_f32_4x4x4_16b_bf16 v[24:27], v[54:55], v[238:239], v[24:27] cbsz:4 abid:4
    v_mfma_f32_4x4x4_16b_bf16 v[12:15], v[54:55], v[240:241], v[12:15] cbsz:4 abid:8
    v_mfma_f32_4x4x4_16b_bf16 v[16:19], v[54:55], v[242:243], v[16:19] cbsz:4 abid:8
    v_mfma_f32_4x4x4_16b_bf16 v[20:23], v[54:55], v[244:245], v[20:23] cbsz:4 abid:8
    v_mfma_f32_4x4x4_16b_bf16 v[24:27], v[54:55], v[246:247], v[24:27] cbsz:4 abid:8
    v_mfma_f32_4x4x4_16b_bf16 v[12:15], v[54:55], v[248:249], v[12:15] cbsz:4 abid:12
    v_mfma_f32_4x4x4_16b_bf16 v[16:19], v[54:55], v[250:251], v[16:19] cbsz:4 abid:12
    v_mfma_f32_4x4x4_16b_bf16 v[20:23], v[54:55], v[252:253], v[20:23] cbsz:4 abid:12
    v_mfma_f32_4x4x4_16b_bf16 v[24:27], v[54:55], v[254:255], v[24:27] cbsz:4 abid:12
L_p1_44:
    s_lshl_b32 s76, s42, 11
    v_lshl_add_u32 v28, v0, 2, s76
    v_add_u32 v28, 14336, v28
    ds_write2st64_b32 v28, v12, v13 offset0:0 offset1:4
    ds_write2st64_b32 v28, v16, v17 offset0:1 offset1:5
    ds_write2st64_b32 v28, v20, v21 offset0:2 offset1:6
    ds_write2st64_b32 v28, v24, v25 offset0:3 offset1:7
    s_lshl_b32 s77, s42, 4
    v_lshl_add_u32 v29, v0, 3, s77
    s_mov_b64 exec, 3
    ds_write_b64 v29, v[10:11] offset:10240
    s_mov_b64 exec, -1
    s_lshl_b32 s76, s42, 9
    v_lshl_add_u32 v28, v0, 3, s76
    s_lshr_b32 s77, s42, 1
    s_lshl_b32 s77, s77, 3
    v_mov_b32 v29, s77
    s_lshr_b32 s55, s54, 1
    s_add_u32 s55, s55, 1
    s_lshl_b32 s76, s45, 11
    s_add_u32 s76, s76, 0x80000
    s_lshl_b32 s78, s51, 7
    s_lshl3_add_u32 s78, s44, s78
    s_lshr_b32 s77, s77, 1
    s_add_u32 s78, s78, s77
    s_add_u32 s78, s78, 0x110800
    s_waitcnt lgkmcnt(0)
    s_barrier
    ds_read_b64 v[12:13], v29 offset:10240
    ds_read_b64 v[14:15], v29 offset:10256
    ds_read_b64 v[16:17], v29 offset:10272
    ds_read_b64 v[18:19], v29 offset:10288
    ds_read_b64 v[20:21], v28 offset:14336
    ds_read_b64 v[22:23], v28 offset:16384
    ds_read_b64 v[24:25], v28 offset:18432
    ds_read_b64 v[26:27], v28 offset:20480
    s_waitcnt lgkmcnt(4)
    v_max3_f32 v10, v12, v14, v16
    v_max_f32 v10, v10, v18
    v_sub_f32 v12, v12, v10
    v_sub_f32 v14, v14, v10
    v_sub_f32 v16, v16, v10
    v_sub_f32 v18, v18, v10
    v_exp_f32 v12, v12
    v_exp_f32 v14, v14
    v_exp_f32 v16, v16
    v_exp_f32 v18, v18
    v_mul_f32 v11, v12, v13
    v_fmac_f32 v11, v14, v15
    v_fmac_f32 v11, v16, v17
    v_fmac_f32 v11, v18, v19
    s_waitcnt lgkmcnt(0)
    v_pk_mul_f32 v[20:21], v[20:21], v[12:13] op_sel_hi:[1,0]
    v_rcp_f32 v32, v11
    v_log_f32 v11, v11
    v_pk_fma_f32 v[20:21], v[22:23], v[14:15], v[20:21] op_sel_hi:[1,0,1]
    v_pk_fma_f32 v[20:21], v[24:25], v[16:17], v[20:21] op_sel_hi:[1,0,1]
    v_pk_fma_f32 v[20:21], v[26:27], v[18:19], v[20:21] op_sel_hi:[1,0,1]
    v_add_f32 v10, v10, v11
    v_pk_mul_f32 v[20:21], v[20:21], v[32:33] op_sel_hi:[1,0]
    v_bfi_b32 v10, -16, v10, s55
    v_bfi_b32 v20, -16, v20, s55
    v_bfi_b32 v21, -16, v21, s55
    s_cmp_eq_u32 s50, 0
    s_cbranch_scc1 L_g_45
    buffer_store_dwordx2 v[20:21], v28, s[12:15], s76 offen
    s_mov_b64 exec, 1
    buffer_store_dword v10, off, s[12:15], s78
    s_branch L_e_46
L_g_45:
    buffer_store_dwordx2 v[20:21], v28, s[12:15], s76 offen sc1
    s_mov_b64 exec, 1
    buffer_store_dword v10, off, s[12:15], s78 sc1
L_e_46:
    s_mov_b64 exec, -1
    s_add_u32 s54, s54, 2
    s_cmp_lt_u32 s54, 8
    s_cbranch_scc1 L_main
    s_sub_u32 s59, s42, 1
    s_cmp_gt_u32 s59, 1
    s_cbranch_scc1 L_o_47
    s_cmp_lg_u32 s42, 2
    s_cbranch_scc1 L_o_47
    s_lshr_b32 s80, s54, 1
    s_add_u32 s80, s80, 1
    s_sub_u32 s80, s80, s59
    s_cmp_eq_u32 s80, 0
    s_cbranch_scc1 L_o_47
    v_lshrrev_b32 v11, 3, v0
    v_mul_u32_u24 v11, 16384, v11
    v_and_b32 v10, 7, v0
    v_lshl_add_u32 v10, v10, 4, v11
    v_and_b32 v11, 56, v0
    s_lshl_b32 s76, s59, 19
    s_add_u32 s76, s76, s52
    s_add_u32 s77, s76, 0x20000
    s_lshl4_add_u32 s81, s59, s51
    s_lshl_b32 s78, s81, 7
    s_lshr_b32 s79, s44, 3
    s_lshl2_add_u32 s78, s79, s78
    s_add_u32 s78, s78, 0x110000
    s_branch L_pf_50
L_pr_49:
    s_mov_b64 exec, vcc
L_pf_50:
    buffer_load_dwordx4 v[12:15], v10, s[12:15], s76 offen sc1
    buffer_load_dwordx4 v[16:19], v10, s[12:15], s77 offen sc1
    buffer_load_dword v20, v11, s[12:15], s78 offen sc1
    buffer_load_dword v21, v11, s[12:15], s78 offen offset:64 sc1
    s_mov_b64 exec, -1
    s_sub_u32 s56, s56, 1
    s_cbranch_scc1 L_exit
    s_waitcnt vmcnt(0)
    v_xor_b32 v22, s80, v12
    v_bitop3_b32 v22, v22, v13, s80 bitop3:0xf6
    v_bitop3_b32 v22, v22, v14, s80 bitop3:0xf6
    v_bitop3_b32 v22, v22, v15, s80 bitop3:0xf6
    v_bitop3_b32 v22, v22, v16, s80 bitop3:0xf6
    v_bitop3_b32 v22, v22, v17, s80 bitop3:0xf6
    v_bitop3_b32 v22, v22, v18, s80 bitop3:0xf6
    v_bitop3_b32 v22, v22, v19, s80 bitop3:0xf6
    v_bitop3_b32 v22, v22, v20, s80 bitop3:0xf6
    v_bitop3_b32 v22, v22, v21, s80 bitop3:0xf6
    v_and_b32 v22, 15, v22
    v_cmp_ne_u32 vcc, 0, v22
    s_cbranch_vccnz L_pr_49
    v_max_f32 v22, v20, v21
    s_nop 1
    v_max_f32_dpp v22, v22, v22 row_ror:8 row_mask:0xf bank_mask:0xf
    v_mov_b32 v23, v22
    s_nop 1
    v_permlane16_swap_b32 v22, v23
    v_max_f32 v22, v22, v23
    v_mov_b32 v23, v22
    s_nop 1
    v_permlane32_swap_b32 v22, v23
    v_max_f32 v22, v22, v23
    v_sub_f32 v20, v20, v22
    v_sub_f32 v21, v21, v22
    v_exp_f32 v20, v20
    v_exp_f32 v21, v21
    s_nop 0
    v_pk_mul_f32 v[12:13], v[12:13], v[20:21] op_sel_hi:[1,0]
    v_pk_mul_f32 v[14:15], v[14:15], v[20:21] op_sel_hi:[1,0]
    v_pk_fma_f32 v[12:13], v[16:17], v[20:21], v[12:13] op_sel:[0,1,0] op_sel_hi:[1,1,1]
    v_pk_fma_f32 v[14:15], v[18:19], v[20:21], v[14:15] op_sel:[0,1,0] op_sel_hi:[1,1,1]
    v_add_f32 v16, v20, v21
    v_add_f32_dpp v12, v12, v12 row_ror:8 row_mask:0xf bank_mask:0xf
    v_add_f32_dpp v13, v13, v13 row_ror:8 row_mask:0xf bank_mask:0xf
    v_add_f32_dpp v14, v14, v14 row_ror:8 row_mask:0xf bank_mask:0xf
    v_add_f32_dpp v15, v15, v15 row_ror:8 row_mask:0xf bank_mask:0xf
    v_add_f32_dpp v16, v16, v16 row_ror:8 row_mask:0xf bank_mask:0xf
    v_mov_b32 v17, v12
    v_mov_b32 v18, v13
    v_mov_b32 v19, v14
    v_mov_b32 v20, v15
    v_mov_b32 v21, v16
    v_permlane16_swap_b32 v12, v17
    v_permlane16_swap_b32 v13, v18
    v_permlane16_swap_b32 v14, v19
    v_permlane16_swap_b32 v15, v20
    v_permlane16_swap_b32 v16, v21
    v_add_f32 v12, v12, v17
    v_add_f32 v13, v13, v18
    v_add_f32 v14, v14, v19
    v_add_f32 v15, v15, v20
    v_add_f32 v16, v16, v21
    v_mov_b32 v17, v12
    v_mov_b32 v18, v13
    v_mov_b32 v19, v14
    v_mov_b32 v20, v15
    v_mov_b32 v21, v16
    v_permlane32_swap_b32 v12, v17
    v_permlane32_swap_b32 v13, v18
    v_permlane32_swap_b32 v14, v19
    v_permlane32_swap_b32 v15, v20
    v_permlane32_swap_b32 v16, v21
    v_add_f32 v12, v12, v17
    v_add_f32 v13, v13, v18
    v_add_f32 v14, v14, v19
    v_add_f32 v15, v15, v20
    v_add_f32 v16, v16, v21
    v_rcp_f32 v16, v16
    s_lshl_b32 s76, s81, 11
    s_add_u32 s76, s76, 0x100000
    s_lshl_b32 s78, s44, 7
    s_add_u32 s78, s78, s76
    v_pk_mul_f32 v[12:13], v[12:13], v[16:17] op_sel_hi:[1,0]
    v_pk_mul_f32 v[14:15], v[14:15], v[16:17] op_sel_hi:[1,0]
    v_cvt_pk_bf16_f32 v13, v12, v13
    v_cvt_pk_bf16_f32 v15, v14, v15
    v_mov_b32 v16, 0xffff0000
    v_lshl_or_b32 v12, v13, 16, s80
    v_lshl_or_b32 v14, v15, 16, s80
    v_and_or_b32 v13, v13, v16, s80
    v_and_or_b32 v15, v15, v16, s80
    s_mov_b64 exec, 0xff
    s_cmp_eq_u32 s50, 0
    s_cbranch_scc1 L_g_51
    buffer_store_dwordx4 v[12:15], v10, s[12:15], s78 offen
    s_nop 0
    s_branch L_e_52
L_g_51:
    buffer_store_dwordx4 v[12:15], v10, s[12:15], s78 offen sc1
L_e_52:
    s_mov_b64 exec, -1
    v_lshrrev_b32 v6, 4, v0
    v_bfe_u32 v7, v0, 2, 2
    v_lshl_add_u32 v6, v6, 3, v7
    v_and_b32 v7, 3, v0
    v_lshlrev_b32 v7, 3, v7
    v_lshl_add_u32 v6, v6, 6, v7
    v_add_u32 v6, s48, v6
    ds_read_b64_tr_b16 v[32:33], v6 offset:0
    ds_read_b64_tr_b16 v[34:35], v6 offset:256
    ds_read_b64_tr_b16 v[36:37], v6 offset:2048
    ds_read_b64_tr_b16 v[38:39], v6 offset:2304
    ds_read_b64_tr_b16 v[40:41], v6 offset:4096
    ds_read_b64_tr_b16 v[42:43], v6 offset:4352
    ds_read_b64_tr_b16 v[44:45], v6 offset:6144
    ds_read_b64_tr_b16 v[46:47], v6 offset:6400
    ds_read_b64_tr_b16 v[48:49], v6 offset:32
    ds_read_b64_tr_b16 v[50:51], v6 offset:288
    ds_read_b64_tr_b16 v[52:53], v6 offset:2080
    ds_read_b64_tr_b16 v[54:55], v6 offset:2336
    ds_read_b64_tr_b16 v[56:57], v6 offset:4128
    ds_read_b64_tr_b16 v[58:59], v6 offset:4384
    ds_read_b64_tr_b16 v[60:61], v6 offset:6176
    ds_read_b64_tr_b16 v[62:63], v6 offset:6432
    s_lshl_b32 s78, s59, 10
    s_add_u32 s78, s78, 26624
    v_lshlrev_b32 v10, 4, v0
    s_nop 0
    s_branch L_pf_54
L_pr_53:
    s_mov_b64 exec, vcc
L_pf_54:
    buffer_load_dwordx4 v[16:19], v10, s[12:15], s76 offen sc1
    buffer_load_dwordx4 v[20:23], v10, s[12:15], s76 offen offset:1024 sc1
    s_mov_b64 exec, -1
    s_sub_u32 s56, s56, 1
    s_cbranch_scc1 L_exit
    s_waitcnt vmcnt(0)
    v_xor_b32 v11, s80, v16
    v_bitop3_b32 v11, v11, v17, s80 bitop3:0xf6
    v_bitop3_b32 v11, v11, v18, s80 bitop3:0xf6
    v_bitop3_b32 v11, v11, v19, s80 bitop3:0xf6
    v_bitop3_b32 v11, v11, v20, s80 bitop3:0xf6
    v_bitop3_b32 v11, v11, v21, s80 bitop3:0xf6
    v_bitop3_b32 v11, v11, v22, s80 bitop3:0xf6
    v_bitop3_b32 v11, v11, v23, s80 bitop3:0xf6
    v_and_b32 v11, 15, v11
    v_cmp_ne_u32 vcc, 0, v11
    s_cbranch_vccnz L_pr_53
    s_mov_b32 s77, 0x07060302
    v_perm_b32 v24, v17, v16, s77
    v_perm_b32 v25, v19, v18, s77
    v_perm_b32 v26, v21, v20, s77
    v_perm_b32 v27, v23, v22, s77
    v_lshlrev_b32 v10, 3, v0
    v_add_u32 v10, s78, v10
    ds_write_b64 v10, v[24:25]
    ds_write_b64 v10, v[26:27] offset:512
    s_branch L_j_48
L_o_47:
    s_waitcnt vmcnt(0)
    v_lshrrev_b32 v6, 4, v0
    v_bfe_u32 v7, v0, 2, 2
    v_lshl_add_u32 v6, v6, 3, v7
    v_and_b32 v7, 3, v0
    v_lshlrev_b32 v7, 3, v7
    v_lshl_add_u32 v6, v6, 6, v7
    v_add_u32 v6, s48, v6
    ds_read_b64_tr_b16 v[32:33], v6 offset:0
    ds_read_b64_tr_b16 v[34:35], v6 offset:256
    ds_read_b64_tr_b16 v[36:37], v6 offset:2048
    ds_read_b64_tr_b16 v[38:39], v6 offset:2304
    ds_read_b64_tr_b16 v[40:41], v6 offset:4096
    ds_read_b64_tr_b16 v[42:43], v6 offset:4352
    ds_read_b64_tr_b16 v[44:45], v6 offset:6144
    ds_read_b64_tr_b16 v[46:47], v6 offset:6400
    ds_read_b64_tr_b16 v[48:49], v6 offset:32
    ds_read_b64_tr_b16 v[50:51], v6 offset:288
    ds_read_b64_tr_b16 v[52:53], v6 offset:2080
    ds_read_b64_tr_b16 v[54:55], v6 offset:2336
    ds_read_b64_tr_b16 v[56:57], v6 offset:4128
    ds_read_b64_tr_b16 v[58:59], v6 offset:4384
    ds_read_b64_tr_b16 v[60:61], v6 offset:6176
    ds_read_b64_tr_b16 v[62:63], v6 offset:6432
L_j_48:
    v_and_b32 v10, 1, v0
    v_and_b32 v11, 48, v0
    v_lshl_add_u32 v10, v10, 10, v11
    s_lshl_b32 s76, s42, 8
    v_add_u32 v10, s76, v10
    v_lshl_add_u32 v11, v0, 2, s76
    v_add_u32 v11, 28672, v11
    s_waitcnt lgkmcnt(0)
    s_barrier
    ds_read_b128 v[12:15], v10 offset:26624
    ds_read_b128 v[16:19], v10 offset:26688
    ds_read_b128 v[20:23], v10 offset:26752
    ds_read_b128 v[24:27], v10 offset:26816
    s_waitcnt lgkmcnt(3)
    v_mfma_f32_16x16x32_bf16 v[6:9], v[12:15], v[32:35], 0
    v_mfma_f32_16x16x32_bf16 v[28:31], v[12:15], v[48:51], 0
    s_waitcnt lgkmcnt(2)
    v_mfma_f32_16x16x32_bf16 v[6:9], v[16:19], v[36:39], v[6:9]
    v_mfma_f32_16x16x32_bf16 v[28:31], v[16:19], v[52:55], v[28:31]
    s_waitcnt lgkmcnt(1)
    v_mfma_f32_16x16x32_bf16 v[6:9], v[20:23], v[40:43], v[6:9]
    v_mfma_f32_16x16x32_bf16 v[28:31], v[20:23], v[56:59], v[28:31]
    s_waitcnt lgkmcnt(0)
    v_mfma_f32_16x16x32_bf16 v[6:9], v[24:27], v[44:47], v[6:9]
    v_mfma_f32_16x16x32_bf16 v[28:31], v[24:27], v[60:63], v[28:31]
    s_mov_b64 exec, 0xffff
    s_nop 6
    ds_write2_b32 v11, v6, v28 offset0:0 offset1:16
    ds_write2_b32 v11, v7, v29 offset0:32 offset1:48
    s_mov_b64 exec, -1
    s_waitcnt lgkmcnt(0)
    s_barrier
    s_sub_u32 s59, s42, 1
    s_cmp_gt_u32 s59, 1
    s_cbranch_scc1 L_o_55
    s_cmp_lg_u32 s42, 2
    s_cbranch_scc1 L_o_55
    s_lshr_b32 s80, s54, 1
    s_add_u32 s80, s80, 1
    s_sub_u32 s80, s80, s59
    s_cmp_eq_u32 s80, 0
    s_cbranch_scc1 L_o_55
    v_lshlrev_b32 v10, 2, v0
    s_lshl_b32 s76, s59, 7
    s_add_u32 s76, s76, 28672
    v_add_u32 v11, s76, v10
    ds_read2st64_b32 v[12:13], v11 offset0:0 offset1:1
    ds_read2st64_b32 v[14:15], v11 offset0:2 offset1:3
    s_mul_i32 s76, s59, 6
    s_add_u32 s76, s76, s54
    s_lshl_b32 s76, s76, 14
    s_add_u32 s76, s76, 0x260000
    s_add_u32 s76, s76, s53
    s_waitcnt lgkmcnt(0)
    v_pk_add_f32 v[12:13], v[12:13], v[14:15]
    v_add_f32 v12, v12, v13
    v_bfi_b32 v12, -16, v12, 1
    s_mov_b32 exec_hi, 0
    buffer_store_dword v12, v10, s[12:15], s76 offen sc1
    s_mov_b64 exec, -1
L_o_55:
    s_cmp_gt_u32 s26, 7
    s_cbranch_scc1 L_exit
    s_mov_b32 s54, s26
    s_lshl_b32 s84, s54, 11
    s_lshl_b32 s78, s42, 9
    s_add_u32 s84, s84, s78
    s_add_u32 s84, s84, 0x2a8000
    v_and_b32 v7, 31, v0
    v_lshlrev_b32 v7, 4, v7
    buffer_load_dwordx4 v[28:31], v7, s[12:15], s84 offen sc1
    s_lshl_b32 s76, s54, 14
    s_add_u32 s76, s76, 0x280000
    s_add_u32 s76, s76, s78
    s_add_u32 s77, s76, 4096
    v_lshrrev_b32 v9, 5, v0
    v_lshl_add_u32 v9, v9, 13, v7
    s_waitcnt lgkmcnt(0)
    s_barrier
    s_sleep 4
    s_branch L_pf_57
L_pr_56:
    s_mov_b64 exec, vcc
L_pf_57:
    buffer_load_dwordx4 v[10:13], v9, s[12:15], s76 offen offset:0 sc1
    buffer_load_dwordx4 v[14:17], v9, s[12:15], s76 offen offset:2048 sc1
    buffer_load_dwordx4 v[18:21], v9, s[12:15], s77 offen offset:0 sc1
    buffer_load_dwordx4 v[22:25], v9, s[12:15], s77 offen offset:2048 sc1
    s_mov_b64 exec, -1
    s_sub_u32 s56, s56, 1
    s_cbranch_scc1 L_exit
    s_waitcnt vmcnt(0)
    v_xor_b32 v8, 1, v10
    v_bitop3_b32 v8, v8, v11, 1 bitop3:0xf6
    v_bitop3_b32 v8, v8, v12, 1 bitop3:0xf6
    v_bitop3_b32 v8, v8, v13, 1 bitop3:0xf6
    v_bitop3_b32 v8, v8, v14, 1 bitop3:0xf6
    v_bitop3_b32 v8, v8, v15, 1 bitop3:0xf6
    v_bitop3_b32 v8, v8, v16, 1 bitop3:0xf6
    v_bitop3_b32 v8, v8, v17, 1 bitop3:0xf6
    v_bitop3_b32 v8, v8, v18, 1 bitop3:0xf6
    v_bitop3_b32 v8, v8, v19, 1 bitop3:0xf6
    v_bitop3_b32 v8, v8, v20, 1 bitop3:0xf6
    v_bitop3_b32 v8, v8, v21, 1 bitop3:0xf6
    v_bitop3_b32 v8, v8, v22, 1 bitop3:0xf6
    v_bitop3_b32 v8, v8, v23, 1 bitop3:0xf6
    v_bitop3_b32 v8, v8, v24, 1 bitop3:0xf6
    v_bitop3_b32 v8, v8, v25, 1 bitop3:0xf6
    v_and_b32 v8, 15, v8
    v_cmp_ne_u32 vcc, 0, v8
    s_cbranch_vccnz L_pr_56
    v_pk_add_f32 v[10:11], v[10:11], v[14:15]
    v_pk_add_f32 v[12:13], v[12:13], v[16:17]
    v_pk_add_f32 v[18:19], v[18:19], v[22:23]
    v_pk_add_f32 v[20:21], v[20:21], v[24:25]
    v_pk_add_f32 v[10:11], v[10:11], v[18:19]
    v_pk_add_f32 v[12:13], v[12:13], v[20:21]
    v_mov_b32 v14, v10
    v_mov_b32 v15, v11
    v_mov_b32 v16, v12
    v_mov_b32 v17, v13
    v_permlane32_swap_b32 v10, v14
    v_permlane32_swap_b32 v11, v15
    v_permlane32_swap_b32 v12, v16
    v_permlane32_swap_b32 v13, v17
    v_add_f32 v10, v10, v14
    v_add_f32 v11, v11, v15
    v_add_f32 v12, v12, v16
    v_add_f32 v13, v13, v17
    v_cvt_pk_bf16_f32 v11, v10, v11
    v_cvt_pk_bf16_f32 v13, v12, v13
    v_lshlrev_b32 v10, 16, v11
    v_and_b32 v11, 0xffff0000, v11
    v_lshlrev_b32 v12, 16, v13
    v_and_b32 v13, 0xffff0000, v13
    v_pk_add_f32 v[10:11], v[10:11], v[28:29]
    v_pk_add_f32 v[12:13], v[12:13], v[30:31]
    v_cvt_pk_bf16_f32 v11, v10, v11
    v_cvt_pk_bf16_f32 v13, v12, v13
    v_lshlrev_b32 v10, 16, v11
    v_and_b32 v11, 0xffff0000, v11
    v_lshlrev_b32 v12, 16, v13
    v_and_b32 v13, 0xffff0000, v13
    s_xor_b32 s60, s60, 64
    v_readlane_b32 s79, v10, 0
    s_mov_b32 vcc_lo, 0x7f7f7f7f
    s_mov_b32 vcc_hi, 0x7f7f7f7f
    s_lshl4_add_u32 s78, s42, s60
    v_subrev_f32 v14, s79, v10
    v_subrev_f32 v15, s79, v11
    v_subrev_f32 v16, s79, v12
    v_subrev_f32 v17, s79, v13
    v_mov_b32 v22, s78
    v_pk_mul_f32 v[20:21], v[14:15], v[14:15]
    v_pk_add_f32 v[18:19], v[14:15], v[16:17]
    v_pk_fma_f32 v[20:21], v[16:17], v[16:17], v[20:21]
    v_add_f32 v18, v18, v19
    v_and_b32 v23, 3, v0
    v_add_f32 v19, v20, v21
    v_mov_b32 v20, s79
    v_cndmask_b32 v18, 0, v18, vcc
    v_cndmask_b32 v19, 0, v19, vcc
    v_lshl_add_u32 v23, v23, 4, s60
    v_add_f32_dpp v18, v18, v18 quad_perm:[1,0,3,2] row_mask:0xf bank_mask:0xf
    v_add_f32_dpp v19, v19, v19 quad_perm:[1,0,3,2] row_mask:0xf bank_mask:0xf
    s_nop 0
    v_add_f32_dpp v18, v18, v18 quad_perm:[2,3,0,1] row_mask:0xf bank_mask:0xf
    v_add_f32_dpp v19, v19, v19 quad_perm:[2,3,0,1] row_mask:0xf bank_mask:0xf
    s_nop 0
    v_add_f32_dpp v18, v18, v18 row_half_mirror row_mask:0xf bank_mask:0xf
    v_add_f32_dpp v19, v19, v19 row_half_mirror row_mask:0xf bank_mask:0xf
    s_nop 0
    v_add_f32_dpp v18, v18, v18 row_mirror row_mask:0xf bank_mask:0xf
    v_add_f32_dpp v19, v19, v19 row_mirror row_mask:0xf bank_mask:0xf
    s_nop 0
    v_add_f32_dpp v18, v18, v18 row_bcast:15 row_mask:0xa bank_mask:0xf
    v_add_f32_dpp v19, v19, v19 row_bcast:15 row_mask:0xa bank_mask:0xf
    s_mov_b32 exec_lo, 0x80000000
    s_mov_b32 exec_hi, 0
    ds_write_b128 v22, v[18:21] offset:10304
    s_mov_b64 exec, -1
    v_mov_b32 v24, 0x42e00000
    s_waitcnt lgkmcnt(0)
    s_barrier
    ds_read_b128 v[14:17], v23 offset:10304
    s_waitcnt lgkmcnt(0)
    v_fma_f32 v26, v16, v24, v14
    v_mul_f32 v14, -2.0, v14
    s_nop 0
    v_add_f32_dpp v26, v26, v26 quad_perm:[1,0,3,2] row_mask:0xf bank_mask:0xf
    s_nop 1
    v_add_f32_dpp v26, v26, v26 quad_perm:[2,3,0,1] row_mask:0xf bank_mask:0xf
    v_mul_f32 v26, 0x3b124925, v26
    v_sub_f32 v16, v26, v16
    v_fmac_f32 v14, v16, v24
    v_fmac_f32 v15, v16, v14
    s_nop 1
    v_add_f32_dpp v15, v15, v15 quad_perm:[1,0,3,2] row_mask:0xf bank_mask:0xf
    s_nop 1
    v_add_f32_dpp v15, v15, v15 quad_perm:[2,3,0,1] row_mask:0xf bank_mask:0xf
    v_mul_f32 v27, 0x3b124925, v15
    v_max_f32 v27, 0, v27
    v_cvt_pk_bf16_f32 v29, v26, v27
    v_lshlrev_b32 v28, 16, v29
    v_and_b32 v29, 0xffff0000, v29
    v_add_f32 v29, 0x3727c5ac, v29
    v_cvt_pk_bf16_f32 v29, v29, v29
    v_lshlrev_b32 v29, 16, v29
    v_sqrt_f32 v29, v29
    s_nop 0
    v_cvt_pk_bf16_f32 v29, v29, v29
    v_lshlrev_b32 v29, 16, v29
    v_rcp_f32 v29, v29
    v_sub_f32 v26, v26, v28
    v_mul_f32 v27, v27, v29
    v_mul_f32 v26, v26, v29
    v_mul_f32 v27, v27, v29
    v_pk_add_f32 v[18:19], v[10:11], v[28:29] op_sel_hi:[1,0] neg_lo:[0,1] neg_hi:[0,1]
    v_pk_add_f32 v[20:21], v[12:13], v[28:29] op_sel_hi:[1,0] neg_lo:[0,1] neg_hi:[0,1]
    v_cvt_pk_bf16_f32 v19, v18, v19
    v_cvt_pk_bf16_f32 v21, v20, v21
    v_lshlrev_b32 v18, 16, v19
    v_and_b32 v19, 0xffff0000, v19
    v_lshlrev_b32 v20, 16, v21
    v_and_b32 v21, 0xffff0000, v21
    v_pk_mul_f32 v[18:19], v[18:19], v[28:29] op_sel:[0,1] op_sel_hi:[1,1]
    v_pk_mul_f32 v[20:21], v[20:21], v[28:29] op_sel:[0,1] op_sel_hi:[1,1]
    v_cvt_pk_bf16_f32 v19, v18, v19
    v_cvt_pk_bf16_f32 v21, v20, v21
    v_lshlrev_b32 v18, 16, v19
    v_and_b32 v19, 0xffff0000, v19
    v_lshlrev_b32 v20, 16, v21
    v_and_b32 v21, 0xffff0000, v21
    v_cvt_pk_bf16_f32 v29, v26, v27
    v_lshlrev_b32 v28, 16, v29
    v_and_b32 v29, 0xffff0000, v29
    v_add_f32 v29, 0x3727c5ac, v29
    v_cvt_pk_bf16_f32 v29, v29, v29
    v_lshlrev_b32 v29, 16, v29
    v_sqrt_f32 v29, v29
    s_nop 0
    v_cvt_pk_bf16_f32 v29, v29, v29
    v_lshlrev_b32 v29, 16, v29
    v_rcp_f32 v29, v29
    s_nop 0
    v_pk_add_f32 v[18:19], v[18:19], v[28:29] op_sel_hi:[1,0] neg_lo:[0,1] neg_hi:[0,1]
    v_pk_add_f32 v[20:21], v[20:21], v[28:29] op_sel_hi:[1,0] neg_lo:[0,1] neg_hi:[0,1]
    v_cvt_pk_bf16_f32 v19, v18, v19
    v_cvt_pk_bf16_f32 v21, v20, v21
    v_lshlrev_b32 v18, 16, v19
    v_and_b32 v19, 0xffff0000, v19
    v_lshlrev_b32 v20, 16, v21
    v_and_b32 v21, 0xffff0000, v21
    v_pk_mul_f32 v[18:19], v[18:19], v[28:29] op_sel:[0,1] op_sel_hi:[1,1]
    v_pk_mul_f32 v[20:21], v[20:21], v[28:29] op_sel:[0,1] op_sel_hi:[1,1]
    v_cvt_pk_bf16_f32 v19, v18, v19
    v_cvt_pk_bf16_f32 v21, v20, v21
    v_lshlrev_b32 v18, 16, v19
    v_and_b32 v19, 0xffff0000, v19
    v_lshlrev_b32 v20, 16, v21
    v_and_b32 v21, 0xffff0000, v21
    v_lshrrev_b32 v22, 31, v18
    v_lshrrev_b32 v23, 31, v19
    v_lshrrev_b32 v24, 31, v20
    v_lshrrev_b32 v25, 31, v21
    v_bfe_u32 v18, v18, 14, 17
    v_bfe_u32 v19, v19, 14, 17
    v_bfe_u32 v20, v20, 14, 17
    v_bfe_u32 v21, v21, 14, 17
    v_lshl_add_u32 v18, v22, 1, v18
    v_lshl_add_u32 v19, v23, 1, v19
    v_lshl_add_u32 v20, v24, 1, v20
    v_lshl_add_u32 v21, v25, 1, v21
    v_subrev_u32 v18, 56832, v18
    v_subrev_u32 v19, 56832, v19
    v_subrev_u32 v20, 56832, v20
    v_subrev_u32 v21, 56832, v21
    v_min_u32 v22, 10238, v18
    v_min_u32 v23, 10238, v19
    v_min_u32 v24, 10238, v20
    v_min_u32 v25, 10238, v21
    ds_read_u16 v22, v22 offset:0
    ds_read_u16 v23, v23 offset:0
    ds_read_u16 v24, v24 offset:0
    ds_read_u16 v25, v25 offset:0
    v_max3_u32 v8, v18, v19, v20
    v_max_u32 v8, v8, v21
    v_cmp_lt_u32 vcc, 10239, v8
    s_waitcnt lgkmcnt(0)
    s_and_b32 s78, vcc_lo, 0x7f7f7f7f
    v_lshlrev_b32 v22, 16, v22
    v_lshlrev_b32 v23, 16, v23
    v_lshlrev_b32 v24, 16, v24
    v_lshlrev_b32 v25, 16, v25
    s_nop 0
    s_cbranch_scc0 L_ok_58
    v_cmp_lt_u32 vcc, 10239, v18
    s_nop 0
    s_and_b32 s78, vcc_lo, 0x7f7f7f7f
L_fb_59:
    s_cmp_eq_u32 s78, 0
    s_nop 0
    s_cbranch_scc1 L_fe_60
    s_ff1_i32_b32 s80, s78
    s_bitset0_b32 s78, s80
    v_readlane_b32 s76, v18, s80
    s_nop 3
    s_call_b64 s[64:65], L_eval
    s_mov_b32 m0, s80
    s_nop 0
    v_writelane_b32 v22, s76, m0
    s_nop 0
    s_branch L_fb_59
L_fe_60:
    v_cmp_lt_u32 vcc, 10239, v19
    s_nop 0
    s_and_b32 s78, vcc_lo, 0x7f7f7f7f
L_fb_61:
    s_cmp_eq_u32 s78, 0
    s_nop 0
    s_cbranch_scc1 L_fe_62
    s_ff1_i32_b32 s80, s78
    s_bitset0_b32 s78, s80
    v_readlane_b32 s76, v19, s80
    s_nop 3
    s_call_b64 s[64:65], L_eval
    s_mov_b32 m0, s80
    s_nop 0
    v_writelane_b32 v23, s76, m0
    s_nop 0
    s_branch L_fb_61
L_fe_62:
    v_cmp_lt_u32 vcc, 10239, v20
    s_nop 0
    s_and_b32 s78, vcc_lo, 0x7f7f7f7f
L_fb_63:
    s_cmp_eq_u32 s78, 0
    s_nop 0
    s_cbranch_scc1 L_fe_64
    s_ff1_i32_b32 s80, s78
    s_bitset0_b32 s78, s80
    v_readlane_b32 s76, v20, s80
    s_nop 3
    s_call_b64 s[64:65], L_eval
    s_mov_b32 m0, s80
    s_nop 0
    v_writelane_b32 v24, s76, m0
    s_nop 0
    s_branch L_fb_63
L_fe_64:
    v_cmp_lt_u32 vcc, 10239, v21
    s_nop 0
    s_and_b32 s78, vcc_lo, 0x7f7f7f7f
L_fb_65:
    s_cmp_eq_u32 s78, 0
    s_nop 0
    s_cbranch_scc1 L_fe_66
    s_ff1_i32_b32 s80, s78
    s_bitset0_b32 s78, s80
    v_readlane_b32 s76, v21, s80
    s_nop 3
    s_call_b64 s[64:65], L_eval
    s_mov_b32 m0, s80
    s_nop 0
    v_writelane_b32 v25, s76, m0
    s_nop 0
    s_branch L_fb_65
L_fe_66:
L_ok_58:
    v_pk_add_f32 v[10:11], v[10:11], v[22:23]
    v_pk_add_f32 v[12:13], v[12:13], v[24:25]
    v_cvt_pk_bf16_f32 v14, v10, v11
    v_cvt_pk_bf16_f32 v15, v12, v13
    v_bfe_u32 v8, v0, 3, 2
    v_and_b32 v9, 7, v0
    v_min_u32 v9, 6, v9
    v_lshlrev_b32 v9, 2, v9
    v_mad_u32_u24 v8, v8, 28, v9
    s_mul_i32 s77, s54, 896
    s_mul_i32 s78, s42, 224
    s_add_u32 s77, s77, s78
    v_lshl_add_u32 v8, v8, 1, s77
    s_mov_b32 exec_hi, 0
    s_mov_b32 exec_lo, 0x7f7f7f7f
    global_store_dwordx2 v8, v[14:15], s[36:37]
    s_mov_b64 exec, -1
L_exit:
    s_endpgm
L_bfirst:
    s_mov_b32 s82, 0xbdd2d3e8
    s_mov_b32 s83, s82
    v_mov_b32 v12, 0xc0135761
    v_mov_b32 v13, v12
    s_mul_i32 s85, s86, 10
    s_add_u32 s85, s85, 28416
    s_mov_b32 s84, 0
    v_mov_b32 v47, 0
    s_mov_b32 s71, 0
L_tbl:
    s_add_u32 s76, s71, 3
    s_mov_b32 s89, s76
    s_call_b64 s[74:75], L_pieces
    s_call_b64 s[62:63], L_tb1
    s_call_b64 s[62:63], L_tb2
    s_cmp_lt_u32 s84, 7
    s_cbranch_scc1 L_tbl
    v_mov_b32 v60, 0
    s_nop 0
    s_call_b64 s[62:63], L_gochk
    s_mov_b32 s89, 24
    s_call_b64 s[74:75], L_pieces
    s_waitcnt vmcnt(16)
    v_xor_b32 v6, 64, v4
    v_xor_b32 v7, 128, v4
    v_xor_b32 v8, 192, v4
    ds_read_b128 a[0:3], v4 offset:0
    ds_read_b128 a[4:7], v6 offset:0
    ds_read_b128 a[8:11], v7 offset:0
    ds_read_b128 a[12:15], v8 offset:0
    ds_read_b128 a[16:19], v4 offset:256
    ds_read_b128 a[20:23], v6 offset:256
    ds_read_b128 a[24:27], v7 offset:256
    ds_read_b128 a[28:31], v8 offset:256
    s_add_u32 m0, s48, 24576
    v_xor_b32 v3, 0x18000, v1
    buffer_load_dwordx4 v3, s[4:7], s47 offen nt lds
    s_add_u32 m0, s48, 25600
    v_xor_b32 v3, 0x19020, v1
    buffer_load_dwordx4 v3, s[4:7], s47 offen nt lds
    s_add_u32 m0, s48, 26624
    v_xor_b32 v3, 0x1a040, v1
    buffer_load_dwordx4 v3, s[4:7], s47 offen nt lds
    s_add_u32 m0, s48, 27648
    v_xor_b32 v3, 0x1b060, v1
    buffer_load_dwordx4 v3, s[4:7], s47 offen nt lds
    s_call_b64 s[62:63], L_tb1
    s_add_u32 m0, s48, 28672
    v_xor_b32 v3, 0x1c080, v1
    buffer_load_dwordx4 v3, s[4:7], s47 offen nt lds
    s_add_u32 m0, s48, 29696
    v_xor_b32 v3, 0x1d0a0, v1
    buffer_load_dwordx4 v3, s[4:7], s47 offen nt lds
    s_add_u32 m0, s48, 30720
    v_xor_b32 v3, 0x1e0c0, v1
    buffer_load_dwordx4 v3, s[4:7], s47 offen nt lds
    s_add_u32 m0, s48, 31744
    v_xor_b32 v3, 0x1f0e0, v1
    buffer_load_dwordx4 v3, s[4:7], s47 offen nt lds
    s_call_b64 s[62:63], L_tb2
    s_waitcnt lgkmcnt(0)
    s_waitcnt vmcnt(16)
    v_xor_b32 v6, 64, v4
    v_xor_b32 v7, 128, v4
    v_xor_b32 v8, 192, v4
    ds_read_b128 a[32:35], v4 offset:8192
    ds_read_b128 a[36:39], v6 offset:8192
    ds_read_b128 a[40:43], v7 offset:8192
    ds_read_b128 a[44:47], v8 offset:8192
    ds_read_b128 a[48:51], v4 offset:8448
    ds_read_b128 a[52:55], v6 offset:8448
    ds_read_b128 a[56:59], v7 offset:8448
    ds_read_b128 a[60:63], v8 offset:8448
    s_add_u32 m0, s48, 0
    v_xor_b32 v3, 0x20000, v1
    buffer_load_dwordx4 v3, s[4:7], s47 offen nt lds
    s_add_u32 m0, s48, 1024
    v_xor_b32 v3, 0x21020, v1
    buffer_load_dwordx4 v3, s[4:7], s47 offen nt lds
    s_add_u32 m0, s48, 2048
    v_xor_b32 v3, 0x22040, v1
    buffer_load_dwordx4 v3, s[4:7], s47 offen nt lds
    s_add_u32 m0, s48, 3072
    v_xor_b32 v3, 0x23060, v1
    buffer_load_dwordx4 v3, s[4:7], s47 offen nt lds
    s_call_b64 s[62:63], L_tb1
    s_add_u32 m0, s48, 4096
    v_xor_b32 v3, 0x24080, v1
    buffer_load_dwordx4 v3, s[4:7], s47 offen nt lds
    s_add_u32 m0, s48, 5120
    v_xor_b32 v3, 0x250a0, v1
    buffer_load_dwordx4 v3, s[4:7], s47 offen nt lds
    s_add_u32 m0, s48, 6144
    v_xor_b32 v3, 0x260c0, v1
    buffer_load_dwordx4 v3, s[4:7], s47 offen nt lds
    s_add_u32 m0, s48, 7168
    v_xor_b32 v3, 0x270e0, v1
    buffer_load_dwordx4 v3, s[4:7], s47 offen nt lds
    s_call_b64 s[62:63], L_tb2
    s_waitcnt lgkmcnt(0)
    s_waitcnt vmcnt(16)
    v_xor_b32 v6, 64, v4
    v_xor_b32 v7, 128, v4
    v_xor_b32 v8, 192, v4
    ds_read_b128 a[64:67], v4 offset:16384
    ds_read_b128 a[68:71], v6 offset:16384
    ds_read_b128 a[72:75], v7 offset:16384
    ds_read_b128 a[76:79], v8 offset:16384
    ds_read_b128 a[80:83], v4 offset:16640
    ds_read_b128 a[84:87], v6 offset:16640
    ds_read_b128 a[88:91], v7 offset:16640
    ds_read_b128 a[92:95], v8 offset:16640
    s_add_u32 m0, s48, 8192
    v_xor_b32 v3, 0x28000, v1
    buffer_load_dwordx4 v3, s[4:7], s47 offen nt lds
    s_add_u32 m0, s48, 9216
    v_xor_b32 v3, 0x29020, v1
    buffer_load_dwordx4 v3, s[4:7], s47 offen nt lds
    s_add_u32 m0, s48, 10240
    v_xor_b32 v3, 0x2a040, v1
    buffer_load_dwordx4 v3, s[4:7], s47 offen nt lds
    s_add_u32 m0, s48, 11264
    v_xor_b32 v3, 0x2b060, v1
    buffer_load_dwordx4 v3, s[4:7], s47 offen nt lds
    s_call_b64 s[62:63], L_tb1
    s_add_u32 m0, s48, 12288
    v_xor_b32 v3, 0x2c080, v1
    buffer_load_dwordx4 v3, s[4:7], s47 offen nt lds
    s_add_u32 m0, s48, 13312
    v_xor_b32 v3, 0x2d0a0, v1
    buffer_load_dwordx4 v3, s[4:7], s47 offen nt lds
    s_add_u32 m0, s48, 14336
    v_xor_b32 v3, 0x2e0c0, v1
    buffer_load_dwordx4 v3, s[4:7], s47 offen nt lds
    s_add_u32 m0, s48, 15360
    v_xor_b32 v3, 0x2f0e0, v1
    buffer_load_dwordx4 v3, s[4:7], s47 offen nt lds
    s_call_b64 s[62:63], L_tb2
    s_waitcnt lgkmcnt(0)
    v_lshlrev_b32 v10, 2, v0
    s_mov_b64 exec, 0x3ff
    buffer_store_dword v47, v10, s[12:15], s81 offen sc1
    s_mov_b64 exec, -1
    s_branch L_mid
L_pcs:
    s_lshl_b32 s87, s71, 10
    s_add_u32 m0, s48, s87
    s_and_b32 s87, s71, 7
    s_lshl_b32 s87, s87, 5
    s_lshl_b32 s88, s71, 12
    s_or_b32 s87, s87, s88
    v_xor_b32 v3, s87, v1
    s_add_u32 s71, s71, 1
    buffer_load_dwordx4 v3, s[4:7], s47 offen nt lds
L_pieces:
    s_cmp_lt_u32 s71, s89
    s_cbranch_scc1 L_pcs
    s_setpc_b64 s[74:75]
L_gor:
    s_lshl_b32 s77, s43, 2
    v_mov_b32 v10, s77
    global_load_dword v60, v10, s[38:39] offset:128 sc1
    s_sub_u32 s56, s56, 1
    s_cbranch_scc1 L_exit
    s_waitcnt vmcnt(0)
L_gochk:
    v_cmp_eq_u32 vcc, 0, v60
    s_nop 3
    s_cbranch_vccnz L_gor
    v_readfirstlane_b32 s50, v60
    s_nop 0
    s_and_b32 s50, s50, 1
    s_nop 1
    s_setpc_b64 s[62:63]
L_tb1:
    s_add_u32 s78, s85, s84
    s_lshl_b32 s79, s78, 31
    s_lshr_b32 s78, s78, 1
    s_lshl_b32 s78, s78, 16
    s_or_b32 s78, s78, s79
    v_mov_b32 v44, s78
    v_pk_mul_f32 v[16:17], v[44:45], v[112:113] op_sel_hi:[0,1]
    v_pk_mul_f32 v[18:19], v[44:45], v[114:115] op_sel_hi:[0,1]
    v_pk_mul_f32 v[20:21], v[44:45], v[116:117] op_sel_hi:[0,1]
    v_pk_mul_f32 v[22:23], v[44:45], v[118:119] op_sel_hi:[0,1]
    v_pk_mul_f32 v[24:25], v[44:45], v[120:121] op_sel_hi:[0,1]
    v_pk_mul_f32 v[26:27], v[44:45], v[122:123] op_sel_hi:[0,1]
    v_pk_mul_f32 v[28:29], v[44:45], v[124:125] op_sel_hi:[0,1]
    v_cvt_pk_bf16_f32 v17, v16, v17
    v_cvt_pk_bf16_f32 v19, v18, v19
    v_cvt_pk_bf16_f32 v21, v20, v21
    v_cvt_pk_bf16_f32 v23, v22, v23
    v_cvt_pk_bf16_f32 v25, v24, v25
    v_cvt_pk_bf16_f32 v27, v26, v27
    v_cvt_pk_bf16_f32 v29, v28, v29
    v_lshlrev_b32 v16, 16, v17
    v_lshlrev_b32 v18, 16, v19
    v_lshlrev_b32 v20, 16, v21
    v_lshlrev_b32 v22, 16, v23
    v_lshlrev_b32 v24, 16, v25
    v_lshlrev_b32 v26, 16, v27
    v_lshlrev_b32 v28, 16, v29
    v_and_b32 v17, 0xffff0000, v17
    v_and_b32 v19, 0xffff0000, v19
    v_and_b32 v21, 0xffff0000, v21
    v_and_b32 v23, 0xffff0000, v23
    v_and_b32 v25, 0xffff0000, v25
    v_and_b32 v27, 0xffff0000, v27
    v_and_b32 v29, 0xffff0000, v29
    v_pk_add_f32 v[16:17], v[16:17], v[140:141]
    v_pk_add_f32 v[18:19], v[18:19], v[142:143]
    v_pk_add_f32 v[20:21], v[20:21], v[144:145]
    v_pk_add_f32 v[22:23], v[22:23], v[146:147]
    v_pk_add_f32 v[24:25], v[24:25], v[148:149]
    v_pk_add_f32 v[26:27], v[26:27], v[150:151]
    v_pk_add_f32 v[28:29], v[28:29], v[152:153]
    v_cvt_pk_bf16_f32 v17, v16, v17
    v_cvt_pk_bf16_f32 v19, v18, v19
    v_cvt_pk_bf16_f32 v21, v20, v21
    v_cvt_pk_bf16_f32 v23, v22, v23
    v_cvt_pk_bf16_f32 v25, v24, v25
    v_cvt_pk_bf16_f32 v27, v26, v27
    v_cvt_pk_bf16_f32 v29, v28, v29
    v_lshlrev_b32 v16, 16, v17
    v_lshlrev_b32 v18, 16, v19
    v_lshlrev_b32 v20, 16, v21
    v_lshlrev_b32 v22, 16, v23
    v_lshlrev_b32 v24, 16, v25
    v_lshlrev_b32 v26, 16, v27
    v_lshlrev_b32 v28, 16, v29
    v_and_b32 v17, 0xffff0000, v17
    v_and_b32 v19, 0xffff0000, v19
    v_and_b32 v21, 0xffff0000, v21
    v_and_b32 v23, 0xffff0000, v23
    v_and_b32 v25, 0xffff0000, v25
    v_and_b32 v27, 0xffff0000, v27
    v_and_b32 v29, 0xffff0000, v29
    v_pk_mul_f32 v[30:31], v[16:17], v[16:17]
    v_pk_mul_f32 v[32:33], v[18:19], v[18:19]
    v_pk_mul_f32 v[34:35], v[20:21], v[20:21]
    v_pk_mul_f32 v[36:37], v[22:23], v[22:23]
    v_pk_mul_f32 v[38:39], v[24:25], v[24:25]
    v_pk_mul_f32 v[40:41], v[26:27], v[26:27]
    v_pk_mul_f32 v[42:43], v[28:29], v[28:29]
    v_pk_fma_f32 v[30:31], v[30:31], s[82:83], v[12:13]
    v_pk_fma_f32 v[32:33], v[32:33], s[82:83], v[12:13]
    v_pk_fma_f32 v[34:35], v[34:35], s[82:83], v[12:13]
    v_pk_fma_f32 v[36:37], v[36:37], s[82:83], v[12:13]
    v_pk_fma_f32 v[38:39], v[38:39], s[82:83], v[12:13]
    v_pk_fma_f32 v[40:41], v[40:41], s[82:83], v[12:13]
    v_pk_fma_f32 v[42:43], v[42:43], s[82:83], v[12:13]
    v_pk_mul_f32 v[30:31], v[30:31], v[16:17]
    v_pk_mul_f32 v[32:33], v[32:33], v[18:19]
    v_pk_mul_f32 v[34:35], v[34:35], v[20:21]
    v_pk_mul_f32 v[36:37], v[36:37], v[22:23]
    v_pk_mul_f32 v[38:39], v[38:39], v[24:25]
    v_pk_mul_f32 v[40:41], v[40:41], v[26:27]
    v_pk_mul_f32 v[42:43], v[42:43], v[28:29]
    v_exp_f32 v30, v30
    v_exp_f32 v31, v31
    v_exp_f32 v32, v32
    v_exp_f32 v33, v33
    v_exp_f32 v34, v34
    v_exp_f32 v35, v35
    v_exp_f32 v36, v36
    v_exp_f32 v37, v37
    v_exp_f32 v38, v38
    v_exp_f32 v39, v39
    v_exp_f32 v40, v40
    v_exp_f32 v41, v41
    v_exp_f32 v42, v42
    v_exp_f32 v43, v43
    v_pk_add_f32 v[30:31], v[30:31], 1.0 op_sel_hi:[1,0]
    v_pk_add_f32 v[32:33], v[32:33], 1.0 op_sel_hi:[1,0]
    v_pk_add_f32 v[34:35], v[34:35], 1.0 op_sel_hi:[1,0]
    v_pk_add_f32 v[36:37], v[36:37], 1.0 op_sel_hi:[1,0]
    v_pk_add_f32 v[38:39], v[38:39], 1.0 op_sel_hi:[1,0]
    v_pk_add_f32 v[40:41], v[40:41], 1.0 op_sel_hi:[1,0]
    v_pk_add_f32 v[42:43], v[42:43], 1.0 op_sel_hi:[1,0]
    v_rcp_f32 v30, v30
    v_rcp_f32 v31, v31
    v_rcp_f32 v32, v32
    v_rcp_f32 v33, v33
    v_rcp_f32 v34, v34
    v_rcp_f32 v35, v35
    v_rcp_f32 v36, v36
    v_rcp_f32 v37, v37
    v_rcp_f32 v38, v38
    v_rcp_f32 v39, v39
    v_rcp_f32 v40, v40
    v_rcp_f32 v41, v41
    v_rcp_f32 v42, v42
    v_rcp_f32 v43, v43
    v_pk_mul_f32 v[16:17], v[16:17], v[30:31]
    v_pk_mul_f32 v[18:19], v[18:19], v[32:33]
    v_pk_mul_f32 v[20:21], v[20:21], v[34:35]
    v_pk_mul_f32 v[22:23], v[22:23], v[36:37]
    v_pk_mul_f32 v[24:25], v[24:25], v[38:39]
    v_pk_mul_f32 v[26:27], v[26:27], v[40:41]
    v_pk_mul_f32 v[28:29], v[28:29], v[42:43]
    v_cvt_pk_bf16_f32 v16, v16, v17
    v_cvt_pk_bf16_f32 v18, v18, v19
    v_cvt_pk_bf16_f32 v20, v20, v21
    v_cvt_pk_bf16_f32 v22, v22, v23
    v_cvt_pk_bf16_f32 v24, v24, v25
    v_cvt_pk_bf16_f32 v26, v26, v27
    v_cvt_pk_bf16_f32 v28, v28, v29
    v_dot2_f32_bf16 v14, v16, v92, 0
    v_dot2_f32_bf16 v15, v18, v93, 0
    v_dot2_f32_bf16 v14, v20, v94, v14
    v_dot2_f32_bf16 v15, v22, v95, v15
    v_dot2_f32_bf16 v14, v24, v96, v14
    v_dot2_f32_bf16 v15, v26, v97, v15
    v_dot2_f32_bf16 v14, v28, v98, v14
    s_nop 1
    s_setpc_b64 s[62:63]
L_tb2:
    v_pk_mul_f32 v[16:17], v[44:45], v[126:127] op_sel_hi:[0,1]
    v_pk_mul_f32 v[18:19], v[44:45], v[128:129] op_sel_hi:[0,1]
    v_pk_mul_f32 v[20:21], v[44:45], v[130:131] op_sel_hi:[0,1]
    v_pk_mul_f32 v[22:23], v[44:45], v[132:133] op_sel_hi:[0,1]
    v_pk_mul_f32 v[24:25], v[44:45], v[134:135] op_sel_hi:[0,1]
    v_pk_mul_f32 v[26:27], v[44:45], v[136:137] op_sel_hi:[0,1]
    v_pk_mul_f32 v[28:29], v[44:45], v[138:139] op_sel_hi:[0,1]
    v_cvt_pk_bf16_f32 v17, v16, v17
    v_cvt_pk_bf16_f32 v19, v18, v19
    v_cvt_pk_bf16_f32 v21, v20, v21
    v_cvt_pk_bf16_f32 v23, v22, v23
    v_cvt_pk_bf16_f32 v25, v24, v25
    v_cvt_pk_bf16_f32 v27, v26, v27
    v_cvt_pk_bf16_f32 v29, v28, v29
    v_lshlrev_b32 v16, 16, v17
    v_lshlrev_b32 v18, 16, v19
    v_lshlrev_b32 v20, 16, v21
    v_lshlrev_b32 v22, 16, v23
    v_lshlrev_b32 v24, 16, v25
    v_lshlrev_b32 v26, 16, v27
    v_lshlrev_b32 v28, 16, v29
    v_and_b32 v17, 0xffff0000, v17
    v_and_b32 v19, 0xffff0000, v19
    v_and_b32 v21, 0xffff0000, v21
    v_and_b32 v23, 0xffff0000, v23
    v_and_b32 v25, 0xffff0000, v25
    v_and_b32 v27, 0xffff0000, v27
    v_and_b32 v29, 0xffff0000, v29
    v_pk_add_f32 v[16:17], v[16:17], v[154:155]
    v_pk_add_f32 v[18:19], v[18:19], v[156:157]
    v_pk_add_f32 v[20:21], v[20:21], v[158:159]
    v_pk_add_f32 v[22:23], v[22:23], v[160:161]
    v_pk_add_f32 v[24:25], v[24:25], v[162:163]
    v_pk_add_f32 v[26:27], v[26:27], v[164:165]
    v_pk_add_f32 v[28:29], v[28:29], v[166:167]
    v_cvt_pk_bf16_f32 v17, v16, v17
    v_cvt_pk_bf16_f32 v19, v18, v19
    v_cvt_pk_bf16_f32 v21, v20, v21
    v_cvt_pk_bf16_f32 v23, v22, v23
    v_cvt_pk_bf16_f32 v25, v24, v25
    v_cvt_pk_bf16_f32 v27, v26, v27
    v_cvt_pk_bf16_f32 v29, v28, v29
    v_lshlrev_b32 v16, 16, v17
    v_lshlrev_b32 v18, 16, v19
    v_lshlrev_b32 v20, 16, v21
    v_lshlrev_b32 v22, 16, v23
    v_lshlrev_b32 v24, 16, v25
    v_lshlrev_b32 v26, 16, v27
    v_lshlrev_b32 v28, 16, v29
    v_and_b32 v17, 0xffff0000, v17
    v_and_b32 v19, 0xffff0000, v19
    v_and_b32 v21, 0xffff0000, v21
    v_and_b32 v23, 0xffff0000, v23
    v_and_b32 v25, 0xffff0000, v25
    v_and_b32 v27, 0xffff0000, v27
    v_and_b32 v29, 0xffff0000, v29
    v_pk_mul_f32 v[30:31], v[16:17], v[16:17]
    v_pk_mul_f32 v[32:33], v[18:19], v[18:19]
    v_pk_mul_f32 v[34:35], v[20:21], v[20:21]
    v_pk_mul_f32 v[36:37], v[22:23], v[22:23]
    v_pk_mul_f32 v[38:39], v[24:25], v[24:25]
    v_pk_mul_f32 v[40:41], v[26:27], v[26:27]
    v_pk_mul_f32 v[42:43], v[28:29], v[28:29]
    v_pk_fma_f32 v[30:31], v[30:31], s[82:83], v[12:13]
    v_pk_fma_f32 v[32:33], v[32:33], s[82:83], v[12:13]
    v_pk_fma_f32 v[34:35], v[34:35], s[82:83], v[12:13]
    v_pk_fma_f32 v[36:37], v[36:37], s[82:83], v[12:13]
    v_pk_fma_f32 v[38:39], v[38:39], s[82:83], v[12:13]
    v_pk_fma_f32 v[40:41], v[40:41], s[82:83], v[12:13]
    v_pk_fma_f32 v[42:43], v[42:43], s[82:83], v[12:13]
    v_pk_mul_f32 v[30:31], v[30:31], v[16:17]
    v_pk_mul_f32 v[32:33], v[32:33], v[18:19]
    v_pk_mul_f32 v[34:35], v[34:35], v[20:21]
    v_pk_mul_f32 v[36:37], v[36:37], v[22:23]
    v_pk_mul_f32 v[38:39], v[38:39], v[24:25]
    v_pk_mul_f32 v[40:41], v[40:41], v[26:27]
    v_pk_mul_f32 v[42:43], v[42:43], v[28:29]
    v_exp_f32 v30, v30
    v_exp_f32 v31, v31
    v_exp_f32 v32, v32
    v_exp_f32 v33, v33
    v_exp_f32 v34, v34
    v_exp_f32 v35, v35
    v_exp_f32 v36, v36
    v_exp_f32 v37, v37
    v_exp_f32 v38, v38
    v_exp_f32 v39, v39
    v_exp_f32 v40, v40
    v_exp_f32 v41, v41
    v_exp_f32 v42, v42
    v_exp_f32 v43, v43
    v_pk_add_f32 v[30:31], v[30:31], 1.0 op_sel_hi:[1,0]
    v_pk_add_f32 v[32:33], v[32:33], 1.0 op_sel_hi:[1,0]
    v_pk_add_f32 v[34:35], v[34:35], 1.0 op_sel_hi:[1,0]
    v_pk_add_f32 v[36:37], v[36:37], 1.0 op_sel_hi:[1,0]
    v_pk_add_f32 v[38:39], v[38:39], 1.0 op_sel_hi:[1,0]
    v_pk_add_f32 v[40:41], v[40:41], 1.0 op_sel_hi:[1,0]
    v_pk_add_f32 v[42:43], v[42:43], 1.0 op_sel_hi:[1,0]
    v_rcp_f32 v30, v30
    v_rcp_f32 v31, v31
    v_rcp_f32 v32, v32
    v_rcp_f32 v33, v33
    v_rcp_f32 v34, v34
    v_rcp_f32 v35, v35
    v_rcp_f32 v36, v36
    v_rcp_f32 v37, v37
    v_rcp_f32 v38, v38
    v_rcp_f32 v39, v39
    v_rcp_f32 v40, v40
    v_rcp_f32 v41, v41
    v_rcp_f32 v42, v42
    v_rcp_f32 v43, v43
    v_pk_mul_f32 v[16:17], v[16:17], v[30:31]
    v_pk_mul_f32 v[18:19], v[18:19], v[32:33]
    v_pk_mul_f32 v[20:21], v[20:21], v[34:35]
    v_pk_mul_f32 v[22:23], v[22:23], v[36:37]
    v_pk_mul_f32 v[24:25], v[24:25], v[38:39]
    v_pk_mul_f32 v[26:27], v[26:27], v[40:41]
    v_pk_mul_f32 v[28:29], v[28:29], v[42:43]
    v_cvt_pk_bf16_f32 v16, v16, v17
    v_cvt_pk_bf16_f32 v18, v18, v19
    v_cvt_pk_bf16_f32 v20, v20, v21
    v_cvt_pk_bf16_f32 v22, v22, v23
    v_cvt_pk_bf16_f32 v24, v24, v25
    v_cvt_pk_bf16_f32 v26, v26, v27
    v_cvt_pk_bf16_f32 v28, v28, v29
    v_dot2_f32_bf16 v14, v16, v99, v14
    v_dot2_f32_bf16 v15, v18, v100, v15
    v_dot2_f32_bf16 v14, v20, v101, v14
    v_dot2_f32_bf16 v15, v22, v102, v15
    v_dot2_f32_bf16 v14, v24, v103, v14
    v_dot2_f32_bf16 v15, v26, v104, v15
    v_dot2_f32_bf16 v14, v28, v105, v14
    s_nop 2
    v_add_f32 v14, v14, v15
    s_nop 1
    v_add_f32_dpp v14, v14, v14 quad_perm:[1,0,3,2] row_mask:0xf bank_mask:0xf
    s_nop 1
    v_add_f32_dpp v14, v14, v14 quad_perm:[2,3,0,1] row_mask:0xf bank_mask:0xf
    s_nop 1
    v_add_f32_dpp v14, v14, v14 row_half_mirror row_mask:0xf bank_mask:0xf
    s_nop 1
    v_add_f32_dpp v14, v14, v14 row_mirror row_mask:0xf bank_mask:0xf
    s_nop 1
    v_add_f32_dpp v14, v14, v14 row_bcast:15 row_mask:0xa bank_mask:0xf
    s_nop 1
    v_add_f32_dpp v14, v14, v14 row_bcast:31 row_mask:0xc bank_mask:0xf
    v_cvt_pk_bf16_f32 v14, v14, v14
    v_lshlrev_b32 v14, 16, v14
    v_add_f32 v14, s57, v14
    v_cvt_pk_bf16_f32 v14, v14, v14
    v_lshlrev_b32 v14, 16, v14
    s_nop 0
    v_readlane_b32 s78, v14, 63
    s_nop 0
    s_or_b32 s78, s78, 1
    s_mov_b32 m0, s84
    s_nop 0
    v_writelane_b32 v47, s78, m0
    s_add_u32 s84, s84, 1
    s_setpc_b64 s[62:63]
L_eval:
    s_mov_b32 s82, 0xbdd2d3e8
    s_mov_b32 s83, s82
    v_mov_b32 v62, 0xc0135761
    v_mov_b32 v63, v62
    s_add_u32 s76, s76, 56832
    s_lshl_b32 s77, s76, 30
    s_and_b32 s77, s77, 0x80000000
    s_lshr_b32 s76, s76, 2
    s_lshl_b32 s76, s76, 16
    s_or_b32 s76, s76, s77
    v_mov_b32 v32, s76
    v_mov_b32 v34, 0
    v_mov_b32 v35, 0
    v_lshlrev_b32 v33, 3, v0
    s_mov_b32 s81, 0
L_ev:
    global_load_dwordx2 v[36:37], v33, s[28:29]
    global_load_dwordx2 v[38:39], v33, s[30:31]
    global_load_dwordx2 v[40:41], v33, s[32:33]
    s_waitcnt vmcnt(0)
    v_lshlrev_b32 v42, 16, v36
    v_and_b32 v43, 0xffff0000, v36
    v_lshlrev_b32 v46, 16, v38
    v_and_b32 v47, 0xffff0000, v38
    v_lshlrev_b32 v44, 16, v37
    v_and_b32 v45, 0xffff0000, v37
    v_lshlrev_b32 v48, 16, v39
    v_and_b32 v49, 0xffff0000, v39
    v_pk_mul_f32 v[50:51], v[32:33], v[42:43] op_sel_hi:[0,1]
    v_pk_mul_f32 v[52:53], v[32:33], v[44:45] op_sel_hi:[0,1]
    v_cvt_pk_bf16_f32 v51, v50, v51
    v_cvt_pk_bf16_f32 v53, v52, v53
    v_lshlrev_b32 v50, 16, v51
    v_lshlrev_b32 v52, 16, v53
    v_and_b32 v51, 0xffff0000, v51
    v_and_b32 v53, 0xffff0000, v53
    v_pk_add_f32 v[50:51], v[50:51], v[46:47]
    v_pk_add_f32 v[52:53], v[52:53], v[48:49]
    v_cvt_pk_bf16_f32 v51, v50, v51
    v_cvt_pk_bf16_f32 v53, v52, v53
    v_lshlrev_b32 v50, 16, v51
    v_lshlrev_b32 v52, 16, v53
    v_and_b32 v51, 0xffff0000, v51
    v_and_b32 v53, 0xffff0000, v53
    v_pk_mul_f32 v[54:55], v[50:51], v[50:51]
    v_pk_mul_f32 v[56:57], v[52:53], v[52:53]
    v_pk_fma_f32 v[54:55], v[54:55], s[82:83], v[62:63]
    v_pk_fma_f32 v[56:57], v[56:57], s[82:83], v[62:63]
    v_pk_mul_f32 v[54:55], v[54:55], v[50:51]
    v_pk_mul_f32 v[56:57], v[56:57], v[52:53]
    v_exp_f32 v54, v54
    v_exp_f32 v55, v55
    v_exp_f32 v56, v56
    v_exp_f32 v57, v57
    v_pk_add_f32 v[54:55], v[54:55], 1.0 op_sel_hi:[1,0]
    v_pk_add_f32 v[56:57], v[56:57], 1.0 op_sel_hi:[1,0]
    v_rcp_f32 v54, v54
    v_rcp_f32 v55, v55
    v_rcp_f32 v56, v56
    v_rcp_f32 v57, v57
    v_pk_mul_f32 v[50:51], v[50:51], v[54:55]
    v_pk_mul_f32 v[52:53], v[52:53], v[56:57]
    v_cvt_pk_bf16_f32 v50, v50, v51
    v_cvt_pk_bf16_f32 v52, v52, v53
    v_dot2_f32_bf16 v34, v50, v40, v34
    v_dot2_f32_bf16 v35, v52, v41, v35
    v_add_u32 v33, 512, v33
    s_add_u32 s81, s81, 1
    s_cmp_lt_u32 s81, 7
    s_cbranch_scc1 L_ev
    v_add_f32 v34, v34, v35
    s_nop 1
    v_add_f32_dpp v34, v34, v34 quad_perm:[1,0,3,2] row_mask:0xf bank_mask:0xf
    s_nop 1
    v_add_f32_dpp v34, v34, v34 quad_perm:[2,3,0,1] row_mask:0xf bank_mask:0xf
    s_nop 1
    v_add_f32_dpp v34, v34, v34 row_half_mirror row_mask:0xf bank_mask:0xf
    s_nop 1
    v_add_f32_dpp v34, v34, v34 row_mirror row_mask:0xf bank_mask:0xf
    s_nop 1
    v_add_f32_dpp v34, v34, v34 row_bcast:15 row_mask:0xa bank_mask:0xf
    s_nop 1
    v_add_f32_dpp v34, v34, v34 row_bcast:31 row_mask:0xc bank_mask:0xf
    v_cvt_pk_bf16_f32 v34, v34, v34
    v_lshlrev_b32 v34, 16, v34
    v_add_f32 v34, s57, v34
    v_cvt_pk_bf16_f32 v34, v34, v34
    v_lshlrev_b32 v34, 16, v34
    s_nop 0
    v_readlane_b32 s76, v34, 63
    s_nop 3
    s_setpc_b64 s[64:65]
L_code_end:
.section .rodata,"a"
.p2align 6
.amdhsa_kernel interleave_layers__gqa_block_cached__mixer_token_mlp__decode_kernel
  .amdhsa_next_free_vgpr 512
  .amdhsa_next_free_sgpr 98
  .amdhsa_accum_offset 256
  .amdhsa_group_segment_fixed_size 0
  .amdhsa_kernarg_size 104
  .amdhsa_user_sgpr_count 2
  .amdhsa_user_sgpr_kernarg_segment_ptr 1
  .amdhsa_system_sgpr_workgroup_id_x 1
  .amdhsa_float_denorm_mode_32 3
.end_amdhsa_kernel
```
